```python
import torch

def _softmax(x, axis=-1):
    return torch.softmax(x, dim=axis)
def _gelu(x):
    return torch.nn.functional.gelu(x, approximate="tanh")
def _silu(x):
    return torch.nn.functional.silu(x)
def _sigmoid(x):
    return torch.sigmoid(x)
def _layernorm(x, axis=-1, eps=1e-5):
    m = x.mean(dim=axis, keepdim=True)
    v = x.var(dim=axis, keepdim=True, unbiased=False)
    return (x - m) / torch.sqrt(v + eps)
def _scatter_add(tgt, idx, src, axis=0):
    return tgt.clone().index_add_(axis, idx, src)
def _segment_sum(src, seg, n):
    out = torch.zeros((n,) + src.shape[1:], dtype=src.dtype)
    return out.index_add_(0, seg, src)
def _pad(x, pw):
    flat = tuple(v for pair in reversed(pw) for v in pair)
    return torch.nn.functional.pad(x, flat)

kernel_name = 'standalone__softmax_full_bidir__decode'

def setup_inputs():

    _w = (lambda a: (lambda t: t.to(torch.bfloat16) if t.is_floating_point() else t)(torch.as_tensor(a)))
    B, H, Sq, Skv, Dh = 4, 32, 1, 4096, 128
    return {
        "q": _w((lambda *s: torch.randn(*s, dtype=torch.bfloat16) * 0.8)(B, H, Sq, Dh)),
        "k": _w((lambda *s: torch.randn(*s, dtype=torch.bfloat16) * 0.8)(B, H, Skv, Dh)),
        "v": _w((lambda *s: torch.randn(*s, dtype=torch.bfloat16) * 0.05)(B, H, Skv, Dh)),
    }

def reference(q, k, v):
    scale = q.shape[-1] ** -0.5
    scores = torch.einsum('bhqd,bhkd->bhqk', q, k) * scale
    attn = _softmax(scores, axis=-1)
    return torch.einsum('bhqk,bhkd->bhqd', attn, v)
```

```asm
; @launch grid=(256,1,1) block=(512,1,1) lds=4352
.amdgcn_target "amdgcn-amd-amdhsa--gfx950"
.text
.globl standalone__softmax_full_bidir__decode_kernel
.p2align 8
.type standalone__softmax_full_bidir__decode_kernel,@function
standalone__softmax_full_bidir__decode_kernel:
    s_cmp_ge_u32 s2, 256
    s_cbranch_scc1 L_done
    s_load_dwordx4 s[4:7], s[0:1], 0
    s_load_dwordx4 s[8:11], s[0:1], 16
    s_load_dwordx4 s[12:15], s[0:1], 32
    s_and_b32 s18, s2, 1
    s_lshr_b32 s17, s2, 1
    v_lshrrev_b32 v2, 6, v0
    v_and_b32 v3, 63, v0
    v_readfirstlane_b32 s19, v2
    v_and_b32 v84, 15, v0
    v_lshlrev_b32 v84, 4, v84
    s_lshl_b32 s20, s17, 20
    s_mul_i32 s21, s18, 557056
    s_add_u32 s21, s20, s21
    s_mul_i32 s23, s19, 61440
    s_add_u32 s21, s21, s23
    s_mul_i32 s23, s19, 8192
    s_add_u32 s23, s23, 491520
    s_add_u32 s23, s23, s20
    v_lshlrev_b32 v1, 4, v3
    v_add_u32 v2, s23, v1
    v_add_u32 v1, s21, v1
    s_lshl_b32 s22, s17, 8
    s_lshr_b32 s80, s17, 1
    s_lshl_b32 s80, s80, 2
    s_and_b32 s81, s17, 1
    s_lshl_b32 s81, s81, 4
    s_getreg_b32 s86, hwreg(HW_REG_XCC_ID)
    s_and_b32 s86, s86, 1
    s_xor_b32 s86, s86, 1
    s_waitcnt lgkmcnt(0)
    s_mov_b32 s24, s6
    s_mov_b32 s25, s7
    s_mov_b32 s26, 0x8000000
    s_mov_b32 s27, 0x00020000
    s_mov_b32 s28, s8
    s_mov_b32 s29, s9
    s_mov_b32 s30, 0x8000000
    s_mov_b32 s31, 0x00020000
    s_mov_b32 s32, s4
    s_mov_b32 s33, s5
    s_mov_b32 s34, 0x8000
    s_mov_b32 s35, 0x00020000
    s_mov_b32 s52, s12
    s_mov_b32 s53, s13
    s_mov_b32 s54, 256
    s_mov_b32 s55, 0x00020000
    s_cmp_lg_u32 s19, 0
    s_cbranch_scc1 L_norole
    s_lshl_b32 s82, s86, 9
    s_add_u32 s82, s82, 0x100
    s_lshl_b32 s82, s82, s81
    v_mov_b32 v98, s82
    v_mov_b32 v99, s80
    s_mov_b64 exec, 1
    buffer_atomic_add v98, v99, s[52:55], 0 offen sc0 sc1
    s_mov_b64 exec, -1
L_norole:
    buffer_load_dwordx4 v[4:7], v84, s[32:35], s22 offen
    buffer_load_dwordx4 v[100:103], v1, s[24:27], 0 offen offset:0 nt
    buffer_load_dwordx4 v[104:107], v1, s[24:27], 0 offen offset:1024 nt
    buffer_load_dwordx4 v[108:111], v1, s[24:27], 0 offen offset:2048 nt
    buffer_load_dwordx4 v[112:115], v1, s[24:27], 0 offen offset:3072 nt
    s_mov_b32 s44, 4096
    buffer_load_dwordx4 v[116:119], v1, s[24:27], s44 offen offset:0 nt
    s_mov_b32 s45, 4096
    buffer_load_dwordx4 v[120:123], v1, s[24:27], s45 offen offset:1024 nt
    s_mov_b32 s46, 4096
    buffer_load_dwordx4 v[124:127], v1, s[24:27], s46 offen offset:2048 nt
    s_mov_b32 s47, 4096
    buffer_load_dwordx4 v[128:131], v1, s[24:27], s47 offen offset:3072 nt
    s_mov_b32 s40, 8192
    buffer_load_dwordx4 v[132:135], v1, s[24:27], s40 offen offset:0 nt
    s_mov_b32 s41, 8192
    buffer_load_dwordx4 v[136:139], v1, s[24:27], s41 offen offset:1024 nt
    s_mov_b32 s42, 8192
    buffer_load_dwordx4 v[140:143], v1, s[24:27], s42 offen offset:2048 nt
    s_mov_b32 s43, 8192
    buffer_load_dwordx4 v[144:147], v1, s[24:27], s43 offen offset:3072 nt
    s_mov_b32 s44, 12288
    buffer_load_dwordx4 v[148:151], v1, s[24:27], s44 offen offset:0 nt
    s_mov_b32 s45, 12288
    buffer_load_dwordx4 v[152:155], v1, s[24:27], s45 offen offset:1024 nt
    s_mov_b32 s46, 12288
    buffer_load_dwordx4 v[156:159], v1, s[24:27], s46 offen offset:2048 nt
    s_mov_b32 s47, 12288
    buffer_load_dwordx4 v[160:163], v1, s[24:27], s47 offen offset:3072 nt
    s_mov_b32 s48, s10
    s_mov_b32 s49, s11
    s_mov_b32 s50, 0x8000
    s_mov_b32 s51, 0x00020000
    s_mov_b32 s56, s14
    s_mov_b32 s57, s15
    s_mov_b32 s58, 262144
    s_mov_b32 s59, 0x00020000
    s_mov_b32 s60, 0x3e0293ee
    s_mov_b32 s61, 0xffff0000
    v_mov_b32 v76, 0
    v_mov_b32 v77, 0
    v_mov_b32 v78, 0
    v_mov_b32 v79, 0
    v_mov_b32 v80, 0
    v_mov_b32 v81, 0
    v_mov_b32 v82, 0
    v_mov_b32 v83, 0
    v_mov_b32 v97, 4160
    s_cmp_lg_u32 s19, 0
    s_cbranch_scc1 L_rolebar
    s_waitcnt vmcnt(17)
    v_readfirstlane_b32 s83, v98
    s_nop 3
    s_lshr_b32 s83, s83, s81
    s_lshr_b32 s83, s83, 8
    s_and_b32 s83, s83, 3
    s_lshr_b32 s87, s83, 1
    s_xor_b32 s87, s87, 1
    s_cmp_eq_u32 s83, 0
    s_cselect_b32 s87, s86, s87
    v_mov_b32 v98, s87
    ds_write_b32 v97, v98
    s_waitcnt lgkmcnt(0)
L_rolebar:
    s_barrier
    ds_read_b32 v98, v97
    s_waitcnt vmcnt(15)
    v_dot2_f32_bf16 v8, v100, v4, 0
    v_dot2_f32_bf16 v8, v101, v5, v8
    v_dot2_f32_bf16 v8, v102, v6, v8
    v_dot2_f32_bf16 v8, v103, v7, v8
    s_mov_b32 s40, 16384
    buffer_load_dwordx4 v[100:103], v1, s[24:27], s40 offen offset:0 nt
    s_waitcnt vmcnt(15)
    v_dot2_f32_bf16 v9, v104, v4, 0
    v_dot2_f32_bf16 v9, v105, v5, v9
    v_dot2_f32_bf16 v9, v106, v6, v9
    v_dot2_f32_bf16 v9, v107, v7, v9
    s_mov_b32 s41, 16384
    buffer_load_dwordx4 v[104:107], v1, s[24:27], s41 offen offset:1024 nt
    s_waitcnt vmcnt(15)
    v_dot2_f32_bf16 v10, v108, v4, 0
    v_dot2_f32_bf16 v10, v109, v5, v10
    v_dot2_f32_bf16 v10, v110, v6, v10
    v_dot2_f32_bf16 v10, v111, v7, v10
    s_mov_b32 s42, 16384
    buffer_load_dwordx4 v[108:111], v1, s[24:27], s42 offen offset:2048 nt
    s_waitcnt vmcnt(15)
    v_dot2_f32_bf16 v11, v112, v4, 0
    v_dot2_f32_bf16 v11, v113, v5, v11
    v_dot2_f32_bf16 v11, v114, v6, v11
    v_dot2_f32_bf16 v11, v115, v7, v11
    s_mov_b32 s43, 16384
    buffer_load_dwordx4 v[112:115], v1, s[24:27], s43 offen offset:3072 nt
    s_waitcnt vmcnt(15)
    v_dot2_f32_bf16 v12, v116, v4, 0
    v_dot2_f32_bf16 v12, v117, v5, v12
    v_dot2_f32_bf16 v12, v118, v6, v12
    v_dot2_f32_bf16 v12, v119, v7, v12
    s_mov_b32 s44, 20480
    buffer_load_dwordx4 v[116:119], v1, s[24:27], s44 offen offset:0 nt
    v_add_f32_dpp v8, v8, v8 row_ror:8 row_mask:0xf bank_mask:0xf
    v_add_f32_dpp v9, v9, v9 row_ror:8 row_mask:0xf bank_mask:0xf
    v_add_f32_dpp v10, v10, v10 row_ror:8 row_mask:0xf bank_mask:0xf
    v_add_f32_dpp v11, v11, v11 row_ror:8 row_mask:0xf bank_mask:0xf
    v_add_f32_dpp v8, v8, v8 row_ror:4 row_mask:0xf bank_mask:0xf
    v_add_f32_dpp v9, v9, v9 row_ror:4 row_mask:0xf bank_mask:0xf
    v_add_f32_dpp v10, v10, v10 row_ror:4 row_mask:0xf bank_mask:0xf
    v_add_f32_dpp v11, v11, v11 row_ror:4 row_mask:0xf bank_mask:0xf
    v_add_f32_dpp v8, v8, v8 row_ror:2 row_mask:0xf bank_mask:0xf
    v_add_f32_dpp v9, v9, v9 row_ror:2 row_mask:0xf bank_mask:0xf
    v_add_f32_dpp v10, v10, v10 row_ror:2 row_mask:0xf bank_mask:0xf
    v_add_f32_dpp v11, v11, v11 row_ror:2 row_mask:0xf bank_mask:0xf
    v_add_f32_dpp v8, v8, v8 row_ror:1 row_mask:0xf bank_mask:0xf
    v_add_f32_dpp v9, v9, v9 row_ror:1 row_mask:0xf bank_mask:0xf
    v_add_f32_dpp v10, v10, v10 row_ror:1 row_mask:0xf bank_mask:0xf
    v_add_f32_dpp v11, v11, v11 row_ror:1 row_mask:0xf bank_mask:0xf
    s_waitcnt vmcnt(15)
    v_dot2_f32_bf16 v13, v120, v4, 0
    v_dot2_f32_bf16 v13, v121, v5, v13
    v_dot2_f32_bf16 v13, v122, v6, v13
    v_dot2_f32_bf16 v13, v123, v7, v13
    s_mov_b32 s45, 20480
    buffer_load_dwordx4 v[120:123], v1, s[24:27], s45 offen offset:1024 nt
    s_waitcnt vmcnt(15)
    v_dot2_f32_bf16 v14, v124, v4, 0
    v_dot2_f32_bf16 v14, v125, v5, v14
    v_dot2_f32_bf16 v14, v126, v6, v14
    v_dot2_f32_bf16 v14, v127, v7, v14
    s_mov_b32 s46, 20480
    buffer_load_dwordx4 v[124:127], v1, s[24:27], s46 offen offset:2048 nt
    s_waitcnt vmcnt(15)
    v_dot2_f32_bf16 v15, v128, v4, 0
    v_dot2_f32_bf16 v15, v129, v5, v15
    v_dot2_f32_bf16 v15, v130, v6, v15
    v_dot2_f32_bf16 v15, v131, v7, v15
    s_mov_b32 s47, 20480
    buffer_load_dwordx4 v[128:131], v1, s[24:27], s47 offen offset:3072 nt
    s_waitcnt vmcnt(15)
    v_dot2_f32_bf16 v16, v132, v4, 0
    v_dot2_f32_bf16 v16, v133, v5, v16
    v_dot2_f32_bf16 v16, v134, v6, v16
    v_dot2_f32_bf16 v16, v135, v7, v16
    s_mov_b32 s40, 24576
    buffer_load_dwordx4 v[132:135], v1, s[24:27], s40 offen offset:0 nt
    v_add_f32_dpp v12, v12, v12 row_ror:8 row_mask:0xf bank_mask:0xf
    v_add_f32_dpp v13, v13, v13 row_ror:8 row_mask:0xf bank_mask:0xf
    v_add_f32_dpp v14, v14, v14 row_ror:8 row_mask:0xf bank_mask:0xf
    v_add_f32_dpp v15, v15, v15 row_ror:8 row_mask:0xf bank_mask:0xf
    v_add_f32_dpp v12, v12, v12 row_ror:4 row_mask:0xf bank_mask:0xf
    v_add_f32_dpp v13, v13, v13 row_ror:4 row_mask:0xf bank_mask:0xf
    v_add_f32_dpp v14, v14, v14 row_ror:4 row_mask:0xf bank_mask:0xf
    v_add_f32_dpp v15, v15, v15 row_ror:4 row_mask:0xf bank_mask:0xf
    v_add_f32_dpp v12, v12, v12 row_ror:2 row_mask:0xf bank_mask:0xf
    v_add_f32_dpp v13, v13, v13 row_ror:2 row_mask:0xf bank_mask:0xf
    v_add_f32_dpp v14, v14, v14 row_ror:2 row_mask:0xf bank_mask:0xf
    v_add_f32_dpp v15, v15, v15 row_ror:2 row_mask:0xf bank_mask:0xf
    v_add_f32_dpp v12, v12, v12 row_ror:1 row_mask:0xf bank_mask:0xf
    v_add_f32_dpp v13, v13, v13 row_ror:1 row_mask:0xf bank_mask:0xf
    v_add_f32_dpp v14, v14, v14 row_ror:1 row_mask:0xf bank_mask:0xf
    v_add_f32_dpp v15, v15, v15 row_ror:1 row_mask:0xf bank_mask:0xf
    s_waitcnt vmcnt(15)
    v_dot2_f32_bf16 v17, v136, v4, 0
    v_dot2_f32_bf16 v17, v137, v5, v17
    v_dot2_f32_bf16 v17, v138, v6, v17
    v_dot2_f32_bf16 v17, v139, v7, v17
    s_mov_b32 s41, 24576
    buffer_load_dwordx4 v[136:139], v1, s[24:27], s41 offen offset:1024 nt
    s_waitcnt vmcnt(15)
    v_dot2_f32_bf16 v18, v140, v4, 0
    v_dot2_f32_bf16 v18, v141, v5, v18
    v_dot2_f32_bf16 v18, v142, v6, v18
    v_dot2_f32_bf16 v18, v143, v7, v18
    s_mov_b32 s42, 24576
    buffer_load_dwordx4 v[140:143], v1, s[24:27], s42 offen offset:2048 nt
    s_waitcnt vmcnt(15)
    v_dot2_f32_bf16 v19, v144, v4, 0
    v_dot2_f32_bf16 v19, v145, v5, v19
    v_dot2_f32_bf16 v19, v146, v6, v19
    v_dot2_f32_bf16 v19, v147, v7, v19
    s_mov_b32 s43, 24576
    buffer_load_dwordx4 v[144:147], v1, s[24:27], s43 offen offset:3072 nt
    s_waitcnt vmcnt(15)
    v_dot2_f32_bf16 v20, v148, v4, 0
    v_dot2_f32_bf16 v20, v149, v5, v20
    v_dot2_f32_bf16 v20, v150, v6, v20
    v_dot2_f32_bf16 v20, v151, v7, v20
    s_mov_b32 s44, 28672
    buffer_load_dwordx4 v[148:151], v1, s[24:27], s44 offen offset:0 nt
    v_add_f32_dpp v16, v16, v16 row_ror:8 row_mask:0xf bank_mask:0xf
    v_add_f32_dpp v17, v17, v17 row_ror:8 row_mask:0xf bank_mask:0xf
    v_add_f32_dpp v18, v18, v18 row_ror:8 row_mask:0xf bank_mask:0xf
    v_add_f32_dpp v19, v19, v19 row_ror:8 row_mask:0xf bank_mask:0xf
    v_add_f32_dpp v16, v16, v16 row_ror:4 row_mask:0xf bank_mask:0xf
    v_add_f32_dpp v17, v17, v17 row_ror:4 row_mask:0xf bank_mask:0xf
    v_add_f32_dpp v18, v18, v18 row_ror:4 row_mask:0xf bank_mask:0xf
    v_add_f32_dpp v19, v19, v19 row_ror:4 row_mask:0xf bank_mask:0xf
    v_add_f32_dpp v16, v16, v16 row_ror:2 row_mask:0xf bank_mask:0xf
    v_add_f32_dpp v17, v17, v17 row_ror:2 row_mask:0xf bank_mask:0xf
    v_add_f32_dpp v18, v18, v18 row_ror:2 row_mask:0xf bank_mask:0xf
    v_add_f32_dpp v19, v19, v19 row_ror:2 row_mask:0xf bank_mask:0xf
    v_add_f32_dpp v16, v16, v16 row_ror:1 row_mask:0xf bank_mask:0xf
    v_add_f32_dpp v17, v17, v17 row_ror:1 row_mask:0xf bank_mask:0xf
    v_add_f32_dpp v18, v18, v18 row_ror:1 row_mask:0xf bank_mask:0xf
    v_add_f32_dpp v19, v19, v19 row_ror:1 row_mask:0xf bank_mask:0xf
    s_waitcnt vmcnt(15)
    v_dot2_f32_bf16 v21, v152, v4, 0
    v_dot2_f32_bf16 v21, v153, v5, v21
    v_dot2_f32_bf16 v21, v154, v6, v21
    v_dot2_f32_bf16 v21, v155, v7, v21
    s_mov_b32 s45, 28672
    buffer_load_dwordx4 v[152:155], v1, s[24:27], s45 offen offset:1024 nt
    s_waitcnt vmcnt(15)
    v_dot2_f32_bf16 v22, v156, v4, 0
    v_dot2_f32_bf16 v22, v157, v5, v22
    v_dot2_f32_bf16 v22, v158, v6, v22
    v_dot2_f32_bf16 v22, v159, v7, v22
    s_mov_b32 s46, 28672
    buffer_load_dwordx4 v[156:159], v1, s[24:27], s46 offen offset:2048 nt
    s_waitcnt vmcnt(15)
    v_dot2_f32_bf16 v23, v160, v4, 0
    v_dot2_f32_bf16 v23, v161, v5, v23
    v_dot2_f32_bf16 v23, v162, v6, v23
    v_dot2_f32_bf16 v23, v163, v7, v23
    s_mov_b32 s47, 28672
    buffer_load_dwordx4 v[160:163], v1, s[24:27], s47 offen offset:3072 nt
    s_waitcnt vmcnt(15)
    v_dot2_f32_bf16 v24, v100, v4, 0
    v_dot2_f32_bf16 v24, v101, v5, v24
    v_dot2_f32_bf16 v24, v102, v6, v24
    v_dot2_f32_bf16 v24, v103, v7, v24
    s_mov_b32 s40, 32768
    buffer_load_dwordx4 v[100:103], v1, s[24:27], s40 offen offset:0 nt
    v_add_f32_dpp v20, v20, v20 row_ror:8 row_mask:0xf bank_mask:0xf
    v_add_f32_dpp v21, v21, v21 row_ror:8 row_mask:0xf bank_mask:0xf
    v_add_f32_dpp v22, v22, v22 row_ror:8 row_mask:0xf bank_mask:0xf
    v_add_f32_dpp v23, v23, v23 row_ror:8 row_mask:0xf bank_mask:0xf
    v_add_f32_dpp v20, v20, v20 row_ror:4 row_mask:0xf bank_mask:0xf
    v_add_f32_dpp v21, v21, v21 row_ror:4 row_mask:0xf bank_mask:0xf
    v_add_f32_dpp v22, v22, v22 row_ror:4 row_mask:0xf bank_mask:0xf
    v_add_f32_dpp v23, v23, v23 row_ror:4 row_mask:0xf bank_mask:0xf
    v_add_f32_dpp v20, v20, v20 row_ror:2 row_mask:0xf bank_mask:0xf
    v_add_f32_dpp v21, v21, v21 row_ror:2 row_mask:0xf bank_mask:0xf
    v_add_f32_dpp v22, v22, v22 row_ror:2 row_mask:0xf bank_mask:0xf
    v_add_f32_dpp v23, v23, v23 row_ror:2 row_mask:0xf bank_mask:0xf
    v_add_f32_dpp v20, v20, v20 row_ror:1 row_mask:0xf bank_mask:0xf
    v_add_f32_dpp v21, v21, v21 row_ror:1 row_mask:0xf bank_mask:0xf
    v_add_f32_dpp v22, v22, v22 row_ror:1 row_mask:0xf bank_mask:0xf
    v_add_f32_dpp v23, v23, v23 row_ror:1 row_mask:0xf bank_mask:0xf
    s_waitcnt vmcnt(15)
    v_dot2_f32_bf16 v25, v104, v4, 0
    v_dot2_f32_bf16 v25, v105, v5, v25
    v_dot2_f32_bf16 v25, v106, v6, v25
    v_dot2_f32_bf16 v25, v107, v7, v25
    s_mov_b32 s41, 32768
    buffer_load_dwordx4 v[104:107], v1, s[24:27], s41 offen offset:1024 nt
    s_waitcnt vmcnt(15)
    v_dot2_f32_bf16 v26, v108, v4, 0
    v_dot2_f32_bf16 v26, v109, v5, v26
    v_dot2_f32_bf16 v26, v110, v6, v26
    v_dot2_f32_bf16 v26, v111, v7, v26
    s_mov_b32 s42, 32768
    buffer_load_dwordx4 v[108:111], v1, s[24:27], s42 offen offset:2048 nt
    s_waitcnt vmcnt(15)
    v_dot2_f32_bf16 v27, v112, v4, 0
    v_dot2_f32_bf16 v27, v113, v5, v27
    v_dot2_f32_bf16 v27, v114, v6, v27
    v_dot2_f32_bf16 v27, v115, v7, v27
    s_mov_b32 s43, 32768
    buffer_load_dwordx4 v[112:115], v1, s[24:27], s43 offen offset:3072 nt
    s_waitcnt vmcnt(15)
    v_dot2_f32_bf16 v28, v116, v4, 0
    v_dot2_f32_bf16 v28, v117, v5, v28
    v_dot2_f32_bf16 v28, v118, v6, v28
    v_dot2_f32_bf16 v28, v119, v7, v28
    s_mov_b32 s44, 36864
    buffer_load_dwordx4 v[116:119], v1, s[24:27], s44 offen offset:0 nt
    v_add_f32_dpp v24, v24, v24 row_ror:8 row_mask:0xf bank_mask:0xf
    v_add_f32_dpp v25, v25, v25 row_ror:8 row_mask:0xf bank_mask:0xf
    v_add_f32_dpp v26, v26, v26 row_ror:8 row_mask:0xf bank_mask:0xf
    v_add_f32_dpp v27, v27, v27 row_ror:8 row_mask:0xf bank_mask:0xf
    v_add_f32_dpp v24, v24, v24 row_ror:4 row_mask:0xf bank_mask:0xf
    v_add_f32_dpp v25, v25, v25 row_ror:4 row_mask:0xf bank_mask:0xf
    v_add_f32_dpp v26, v26, v26 row_ror:4 row_mask:0xf bank_mask:0xf
    v_add_f32_dpp v27, v27, v27 row_ror:4 row_mask:0xf bank_mask:0xf
    v_add_f32_dpp v24, v24, v24 row_ror:2 row_mask:0xf bank_mask:0xf
    v_add_f32_dpp v25, v25, v25 row_ror:2 row_mask:0xf bank_mask:0xf
    v_add_f32_dpp v26, v26, v26 row_ror:2 row_mask:0xf bank_mask:0xf
    v_add_f32_dpp v27, v27, v27 row_ror:2 row_mask:0xf bank_mask:0xf
    v_add_f32_dpp v24, v24, v24 row_ror:1 row_mask:0xf bank_mask:0xf
    v_add_f32_dpp v25, v25, v25 row_ror:1 row_mask:0xf bank_mask:0xf
    v_add_f32_dpp v26, v26, v26 row_ror:1 row_mask:0xf bank_mask:0xf
    v_add_f32_dpp v27, v27, v27 row_ror:1 row_mask:0xf bank_mask:0xf
    s_waitcnt vmcnt(15)
    v_dot2_f32_bf16 v29, v120, v4, 0
    v_dot2_f32_bf16 v29, v121, v5, v29
    v_dot2_f32_bf16 v29, v122, v6, v29
    v_dot2_f32_bf16 v29, v123, v7, v29
    s_mov_b32 s45, 36864
    buffer_load_dwordx4 v[120:123], v1, s[24:27], s45 offen offset:1024 nt
    s_waitcnt vmcnt(15)
    v_dot2_f32_bf16 v30, v124, v4, 0
    v_dot2_f32_bf16 v30, v125, v5, v30
    v_dot2_f32_bf16 v30, v126, v6, v30
    v_dot2_f32_bf16 v30, v127, v7, v30
    s_mov_b32 s46, 36864
    buffer_load_dwordx4 v[124:127], v1, s[24:27], s46 offen offset:2048 nt
    s_waitcnt vmcnt(15)
    v_dot2_f32_bf16 v31, v128, v4, 0
    v_dot2_f32_bf16 v31, v129, v5, v31
    v_dot2_f32_bf16 v31, v130, v6, v31
    v_dot2_f32_bf16 v31, v131, v7, v31
    s_mov_b32 s47, 36864
    buffer_load_dwordx4 v[128:131], v1, s[24:27], s47 offen offset:3072 nt
    s_waitcnt vmcnt(15)
    v_dot2_f32_bf16 v32, v132, v4, 0
    v_dot2_f32_bf16 v32, v133, v5, v32
    v_dot2_f32_bf16 v32, v134, v6, v32
    v_dot2_f32_bf16 v32, v135, v7, v32
    s_mov_b32 s40, 40960
    buffer_load_dwordx4 v[132:135], v1, s[24:27], s40 offen offset:0 nt
    v_add_f32_dpp v28, v28, v28 row_ror:8 row_mask:0xf bank_mask:0xf
    v_add_f32_dpp v29, v29, v29 row_ror:8 row_mask:0xf bank_mask:0xf
    v_add_f32_dpp v30, v30, v30 row_ror:8 row_mask:0xf bank_mask:0xf
    v_add_f32_dpp v31, v31, v31 row_ror:8 row_mask:0xf bank_mask:0xf
    v_add_f32_dpp v28, v28, v28 row_ror:4 row_mask:0xf bank_mask:0xf
    v_add_f32_dpp v29, v29, v29 row_ror:4 row_mask:0xf bank_mask:0xf
    v_add_f32_dpp v30, v30, v30 row_ror:4 row_mask:0xf bank_mask:0xf
    v_add_f32_dpp v31, v31, v31 row_ror:4 row_mask:0xf bank_mask:0xf
    v_add_f32_dpp v28, v28, v28 row_ror:2 row_mask:0xf bank_mask:0xf
    v_add_f32_dpp v29, v29, v29 row_ror:2 row_mask:0xf bank_mask:0xf
    v_add_f32_dpp v30, v30, v30 row_ror:2 row_mask:0xf bank_mask:0xf
    v_add_f32_dpp v31, v31, v31 row_ror:2 row_mask:0xf bank_mask:0xf
    v_add_f32_dpp v28, v28, v28 row_ror:1 row_mask:0xf bank_mask:0xf
    v_add_f32_dpp v29, v29, v29 row_ror:1 row_mask:0xf bank_mask:0xf
    v_add_f32_dpp v30, v30, v30 row_ror:1 row_mask:0xf bank_mask:0xf
    v_add_f32_dpp v31, v31, v31 row_ror:1 row_mask:0xf bank_mask:0xf
    s_waitcnt vmcnt(15)
    v_dot2_f32_bf16 v33, v136, v4, 0
    v_dot2_f32_bf16 v33, v137, v5, v33
    v_dot2_f32_bf16 v33, v138, v6, v33
    v_dot2_f32_bf16 v33, v139, v7, v33
    s_mov_b32 s41, 40960
    buffer_load_dwordx4 v[136:139], v1, s[24:27], s41 offen offset:1024 nt
    s_waitcnt vmcnt(15)
    v_dot2_f32_bf16 v34, v140, v4, 0
    v_dot2_f32_bf16 v34, v141, v5, v34
    v_dot2_f32_bf16 v34, v142, v6, v34
    v_dot2_f32_bf16 v34, v143, v7, v34
    s_mov_b32 s42, 40960
    buffer_load_dwordx4 v[140:143], v1, s[24:27], s42 offen offset:2048 nt
    s_waitcnt vmcnt(15)
    v_dot2_f32_bf16 v35, v144, v4, 0
    v_dot2_f32_bf16 v35, v145, v5, v35
    v_dot2_f32_bf16 v35, v146, v6, v35
    v_dot2_f32_bf16 v35, v147, v7, v35
    s_mov_b32 s43, 40960
    buffer_load_dwordx4 v[144:147], v1, s[24:27], s43 offen offset:3072 nt
    s_waitcnt vmcnt(15)
    v_dot2_f32_bf16 v36, v148, v4, 0
    v_dot2_f32_bf16 v36, v149, v5, v36
    v_dot2_f32_bf16 v36, v150, v6, v36
    v_dot2_f32_bf16 v36, v151, v7, v36
    s_mov_b32 s44, 45056
    buffer_load_dwordx4 v[148:151], v1, s[24:27], s44 offen offset:0 nt
    v_add_f32_dpp v32, v32, v32 row_ror:8 row_mask:0xf bank_mask:0xf
    v_add_f32_dpp v33, v33, v33 row_ror:8 row_mask:0xf bank_mask:0xf
    v_add_f32_dpp v34, v34, v34 row_ror:8 row_mask:0xf bank_mask:0xf
    v_add_f32_dpp v35, v35, v35 row_ror:8 row_mask:0xf bank_mask:0xf
    v_add_f32_dpp v32, v32, v32 row_ror:4 row_mask:0xf bank_mask:0xf
    v_add_f32_dpp v33, v33, v33 row_ror:4 row_mask:0xf bank_mask:0xf
    v_add_f32_dpp v34, v34, v34 row_ror:4 row_mask:0xf bank_mask:0xf
    v_add_f32_dpp v35, v35, v35 row_ror:4 row_mask:0xf bank_mask:0xf
    v_add_f32_dpp v32, v32, v32 row_ror:2 row_mask:0xf bank_mask:0xf
    v_add_f32_dpp v33, v33, v33 row_ror:2 row_mask:0xf bank_mask:0xf
    v_add_f32_dpp v34, v34, v34 row_ror:2 row_mask:0xf bank_mask:0xf
    v_add_f32_dpp v35, v35, v35 row_ror:2 row_mask:0xf bank_mask:0xf
    v_add_f32_dpp v32, v32, v32 row_ror:1 row_mask:0xf bank_mask:0xf
    v_add_f32_dpp v33, v33, v33 row_ror:1 row_mask:0xf bank_mask:0xf
    v_add_f32_dpp v34, v34, v34 row_ror:1 row_mask:0xf bank_mask:0xf
    v_add_f32_dpp v35, v35, v35 row_ror:1 row_mask:0xf bank_mask:0xf
    s_waitcnt vmcnt(15)
    v_dot2_f32_bf16 v37, v152, v4, 0
    v_dot2_f32_bf16 v37, v153, v5, v37
    v_dot2_f32_bf16 v37, v154, v6, v37
    v_dot2_f32_bf16 v37, v155, v7, v37
    s_mov_b32 s45, 45056
    buffer_load_dwordx4 v[152:155], v1, s[24:27], s45 offen offset:1024 nt
    s_waitcnt vmcnt(15)
    v_dot2_f32_bf16 v38, v156, v4, 0
    v_dot2_f32_bf16 v38, v157, v5, v38
    v_dot2_f32_bf16 v38, v158, v6, v38
    v_dot2_f32_bf16 v38, v159, v7, v38
    s_mov_b32 s46, 45056
    buffer_load_dwordx4 v[156:159], v1, s[24:27], s46 offen offset:2048 nt
    s_waitcnt vmcnt(15)
    v_dot2_f32_bf16 v39, v160, v4, 0
    v_dot2_f32_bf16 v39, v161, v5, v39
    v_dot2_f32_bf16 v39, v162, v6, v39
    v_dot2_f32_bf16 v39, v163, v7, v39
    s_mov_b32 s47, 45056
    buffer_load_dwordx4 v[160:163], v1, s[24:27], s47 offen offset:3072 nt
    s_waitcnt vmcnt(15)
    v_dot2_f32_bf16 v40, v100, v4, 0
    v_dot2_f32_bf16 v40, v101, v5, v40
    v_dot2_f32_bf16 v40, v102, v6, v40
    v_dot2_f32_bf16 v40, v103, v7, v40
    s_mov_b32 s40, 49152
    buffer_load_dwordx4 v[100:103], v1, s[24:27], s40 offen offset:0 nt
    v_add_f32_dpp v36, v36, v36 row_ror:8 row_mask:0xf bank_mask:0xf
    v_add_f32_dpp v37, v37, v37 row_ror:8 row_mask:0xf bank_mask:0xf
    v_add_f32_dpp v38, v38, v38 row_ror:8 row_mask:0xf bank_mask:0xf
    v_add_f32_dpp v39, v39, v39 row_ror:8 row_mask:0xf bank_mask:0xf
    v_add_f32_dpp v36, v36, v36 row_ror:4 row_mask:0xf bank_mask:0xf
    v_add_f32_dpp v37, v37, v37 row_ror:4 row_mask:0xf bank_mask:0xf
    v_add_f32_dpp v38, v38, v38 row_ror:4 row_mask:0xf bank_mask:0xf
    v_add_f32_dpp v39, v39, v39 row_ror:4 row_mask:0xf bank_mask:0xf
    v_add_f32_dpp v36, v36, v36 row_ror:2 row_mask:0xf bank_mask:0xf
    v_add_f32_dpp v37, v37, v37 row_ror:2 row_mask:0xf bank_mask:0xf
    v_add_f32_dpp v38, v38, v38 row_ror:2 row_mask:0xf bank_mask:0xf
    v_add_f32_dpp v39, v39, v39 row_ror:2 row_mask:0xf bank_mask:0xf
    v_add_f32_dpp v36, v36, v36 row_ror:1 row_mask:0xf bank_mask:0xf
    v_add_f32_dpp v37, v37, v37 row_ror:1 row_mask:0xf bank_mask:0xf
    v_add_f32_dpp v38, v38, v38 row_ror:1 row_mask:0xf bank_mask:0xf
    v_add_f32_dpp v39, v39, v39 row_ror:1 row_mask:0xf bank_mask:0xf
    s_waitcnt vmcnt(15)
    v_dot2_f32_bf16 v41, v104, v4, 0
    v_dot2_f32_bf16 v41, v105, v5, v41
    v_dot2_f32_bf16 v41, v106, v6, v41
    v_dot2_f32_bf16 v41, v107, v7, v41
    s_mov_b32 s41, 49152
    buffer_load_dwordx4 v[104:107], v1, s[24:27], s41 offen offset:1024 nt
    s_waitcnt vmcnt(15)
    v_dot2_f32_bf16 v42, v108, v4, 0
    v_dot2_f32_bf16 v42, v109, v5, v42
    v_dot2_f32_bf16 v42, v110, v6, v42
    v_dot2_f32_bf16 v42, v111, v7, v42
    s_mov_b32 s42, 49152
    buffer_load_dwordx4 v[108:111], v1, s[24:27], s42 offen offset:2048 nt
    s_waitcnt vmcnt(15)
    v_dot2_f32_bf16 v43, v112, v4, 0
    v_dot2_f32_bf16 v43, v113, v5, v43
    v_dot2_f32_bf16 v43, v114, v6, v43
    v_dot2_f32_bf16 v43, v115, v7, v43
    s_mov_b32 s43, 49152
    buffer_load_dwordx4 v[112:115], v1, s[24:27], s43 offen offset:3072 nt
    s_waitcnt vmcnt(15)
    v_dot2_f32_bf16 v44, v116, v4, 0
    v_dot2_f32_bf16 v44, v117, v5, v44
    v_dot2_f32_bf16 v44, v118, v6, v44
    v_dot2_f32_bf16 v44, v119, v7, v44
    s_mov_b32 s44, 53248
    buffer_load_dwordx4 v[116:119], v1, s[24:27], s44 offen offset:0 nt
    v_add_f32_dpp v40, v40, v40 row_ror:8 row_mask:0xf bank_mask:0xf
    v_add_f32_dpp v41, v41, v41 row_ror:8 row_mask:0xf bank_mask:0xf
    v_add_f32_dpp v42, v42, v42 row_ror:8 row_mask:0xf bank_mask:0xf
    v_add_f32_dpp v43, v43, v43 row_ror:8 row_mask:0xf bank_mask:0xf
    v_add_f32_dpp v40, v40, v40 row_ror:4 row_mask:0xf bank_mask:0xf
    v_add_f32_dpp v41, v41, v41 row_ror:4 row_mask:0xf bank_mask:0xf
    v_add_f32_dpp v42, v42, v42 row_ror:4 row_mask:0xf bank_mask:0xf
    v_add_f32_dpp v43, v43, v43 row_ror:4 row_mask:0xf bank_mask:0xf
    v_add_f32_dpp v40, v40, v40 row_ror:2 row_mask:0xf bank_mask:0xf
    v_add_f32_dpp v41, v41, v41 row_ror:2 row_mask:0xf bank_mask:0xf
    v_add_f32_dpp v42, v42, v42 row_ror:2 row_mask:0xf bank_mask:0xf
    v_add_f32_dpp v43, v43, v43 row_ror:2 row_mask:0xf bank_mask:0xf
    v_add_f32_dpp v40, v40, v40 row_ror:1 row_mask:0xf bank_mask:0xf
    v_add_f32_dpp v41, v41, v41 row_ror:1 row_mask:0xf bank_mask:0xf
    v_add_f32_dpp v42, v42, v42 row_ror:1 row_mask:0xf bank_mask:0xf
    v_add_f32_dpp v43, v43, v43 row_ror:1 row_mask:0xf bank_mask:0xf
    s_waitcnt vmcnt(15)
    v_dot2_f32_bf16 v45, v120, v4, 0
    v_dot2_f32_bf16 v45, v121, v5, v45
    v_dot2_f32_bf16 v45, v122, v6, v45
    v_dot2_f32_bf16 v45, v123, v7, v45
    s_mov_b32 s45, 53248
    buffer_load_dwordx4 v[120:123], v1, s[24:27], s45 offen offset:1024 nt
    s_waitcnt vmcnt(15)
    v_dot2_f32_bf16 v46, v124, v4, 0
    v_dot2_f32_bf16 v46, v125, v5, v46
    v_dot2_f32_bf16 v46, v126, v6, v46
    v_dot2_f32_bf16 v46, v127, v7, v46
    s_mov_b32 s46, 53248
    buffer_load_dwordx4 v[124:127], v1, s[24:27], s46 offen offset:2048 nt
    s_waitcnt vmcnt(15)
    v_dot2_f32_bf16 v47, v128, v4, 0
    v_dot2_f32_bf16 v47, v129, v5, v47
    v_dot2_f32_bf16 v47, v130, v6, v47
    v_dot2_f32_bf16 v47, v131, v7, v47
    s_mov_b32 s47, 53248
    buffer_load_dwordx4 v[128:131], v1, s[24:27], s47 offen offset:3072 nt
    s_waitcnt vmcnt(15)
    v_dot2_f32_bf16 v48, v132, v4, 0
    v_dot2_f32_bf16 v48, v133, v5, v48
    v_dot2_f32_bf16 v48, v134, v6, v48
    v_dot2_f32_bf16 v48, v135, v7, v48
    s_mov_b32 s40, 57344
    buffer_load_dwordx4 v[132:135], v1, s[24:27], s40 offen offset:0 nt
    v_add_f32_dpp v44, v44, v44 row_ror:8 row_mask:0xf bank_mask:0xf
    v_add_f32_dpp v45, v45, v45 row_ror:8 row_mask:0xf bank_mask:0xf
    v_add_f32_dpp v46, v46, v46 row_ror:8 row_mask:0xf bank_mask:0xf
    v_add_f32_dpp v47, v47, v47 row_ror:8 row_mask:0xf bank_mask:0xf
    v_add_f32_dpp v44, v44, v44 row_ror:4 row_mask:0xf bank_mask:0xf
    v_add_f32_dpp v45, v45, v45 row_ror:4 row_mask:0xf bank_mask:0xf
    v_add_f32_dpp v46, v46, v46 row_ror:4 row_mask:0xf bank_mask:0xf
    v_add_f32_dpp v47, v47, v47 row_ror:4 row_mask:0xf bank_mask:0xf
    v_add_f32_dpp v44, v44, v44 row_ror:2 row_mask:0xf bank_mask:0xf
    v_add_f32_dpp v45, v45, v45 row_ror:2 row_mask:0xf bank_mask:0xf
    v_add_f32_dpp v46, v46, v46 row_ror:2 row_mask:0xf bank_mask:0xf
    v_add_f32_dpp v47, v47, v47 row_ror:2 row_mask:0xf bank_mask:0xf
    v_add_f32_dpp v44, v44, v44 row_ror:1 row_mask:0xf bank_mask:0xf
    v_add_f32_dpp v45, v45, v45 row_ror:1 row_mask:0xf bank_mask:0xf
    v_add_f32_dpp v46, v46, v46 row_ror:1 row_mask:0xf bank_mask:0xf
    v_add_f32_dpp v47, v47, v47 row_ror:1 row_mask:0xf bank_mask:0xf
    s_waitcnt vmcnt(15)
    v_dot2_f32_bf16 v49, v136, v4, 0
    v_dot2_f32_bf16 v49, v137, v5, v49
    v_dot2_f32_bf16 v49, v138, v6, v49
    v_dot2_f32_bf16 v49, v139, v7, v49
    s_mov_b32 s41, 57344
    buffer_load_dwordx4 v[136:139], v1, s[24:27], s41 offen offset:1024 nt
    s_waitcnt vmcnt(15)
    v_dot2_f32_bf16 v50, v140, v4, 0
    v_dot2_f32_bf16 v50, v141, v5, v50
    v_dot2_f32_bf16 v50, v142, v6, v50
    v_dot2_f32_bf16 v50, v143, v7, v50
    s_mov_b32 s42, 57344
    buffer_load_dwordx4 v[140:143], v1, s[24:27], s42 offen offset:2048 nt
    s_waitcnt vmcnt(15)
    v_dot2_f32_bf16 v51, v144, v4, 0
    v_dot2_f32_bf16 v51, v145, v5, v51
    v_dot2_f32_bf16 v51, v146, v6, v51
    v_dot2_f32_bf16 v51, v147, v7, v51
    s_mov_b32 s43, 57344
    buffer_load_dwordx4 v[144:147], v1, s[24:27], s43 offen offset:3072 nt
    s_waitcnt lgkmcnt(0)
    v_readfirstlane_b32 s87, v98
    s_nop 3
    s_cmp_lg_u32 s87, 0
    s_cbranch_scc1 L_big
    s_waitcnt vmcnt(15)
    v_dot2_f32_bf16 v52, v148, v4, 0
    v_dot2_f32_bf16 v52, v149, v5, v52
    v_dot2_f32_bf16 v52, v150, v6, v52
    v_dot2_f32_bf16 v52, v151, v7, v52
    buffer_load_dwordx4 v[148:151], v1, s[28:31], 0 offen offset:0 nt
    v_add_f32_dpp v48, v48, v48 row_ror:8 row_mask:0xf bank_mask:0xf
    v_add_f32_dpp v49, v49, v49 row_ror:8 row_mask:0xf bank_mask:0xf
    v_add_f32_dpp v50, v50, v50 row_ror:8 row_mask:0xf bank_mask:0xf
    v_add_f32_dpp v51, v51, v51 row_ror:8 row_mask:0xf bank_mask:0xf
    v_add_f32_dpp v48, v48, v48 row_ror:4 row_mask:0xf bank_mask:0xf
    v_add_f32_dpp v49, v49, v49 row_ror:4 row_mask:0xf bank_mask:0xf
    v_add_f32_dpp v50, v50, v50 row_ror:4 row_mask:0xf bank_mask:0xf
    v_add_f32_dpp v51, v51, v51 row_ror:4 row_mask:0xf bank_mask:0xf
    v_add_f32_dpp v48, v48, v48 row_ror:2 row_mask:0xf bank_mask:0xf
    v_add_f32_dpp v49, v49, v49 row_ror:2 row_mask:0xf bank_mask:0xf
    v_add_f32_dpp v50, v50, v50 row_ror:2 row_mask:0xf bank_mask:0xf
    v_add_f32_dpp v51, v51, v51 row_ror:2 row_mask:0xf bank_mask:0xf
    v_add_f32_dpp v48, v48, v48 row_ror:1 row_mask:0xf bank_mask:0xf
    v_add_f32_dpp v49, v49, v49 row_ror:1 row_mask:0xf bank_mask:0xf
    v_add_f32_dpp v50, v50, v50 row_ror:1 row_mask:0xf bank_mask:0xf
    v_add_f32_dpp v51, v51, v51 row_ror:1 row_mask:0xf bank_mask:0xf
    s_waitcnt vmcnt(15)
    v_dot2_f32_bf16 v53, v152, v4, 0
    v_dot2_f32_bf16 v53, v153, v5, v53
    v_dot2_f32_bf16 v53, v154, v6, v53
    v_dot2_f32_bf16 v53, v155, v7, v53
    buffer_load_dwordx4 v[152:155], v1, s[28:31], 0 offen offset:1024 nt
    s_waitcnt vmcnt(15)
    v_dot2_f32_bf16 v54, v156, v4, 0
    v_dot2_f32_bf16 v54, v157, v5, v54
    v_dot2_f32_bf16 v54, v158, v6, v54
    v_dot2_f32_bf16 v54, v159, v7, v54
    buffer_load_dwordx4 v[156:159], v1, s[28:31], 0 offen offset:2048 nt
    s_waitcnt vmcnt(15)
    v_dot2_f32_bf16 v55, v160, v4, 0
    v_dot2_f32_bf16 v55, v161, v5, v55
    v_dot2_f32_bf16 v55, v162, v6, v55
    v_dot2_f32_bf16 v55, v163, v7, v55
    buffer_load_dwordx4 v[160:163], v1, s[28:31], 0 offen offset:3072 nt
    s_waitcnt vmcnt(15)
    v_dot2_f32_bf16 v56, v100, v4, 0
    v_dot2_f32_bf16 v56, v101, v5, v56
    v_dot2_f32_bf16 v56, v102, v6, v56
    v_dot2_f32_bf16 v56, v103, v7, v56
    s_mov_b32 s40, 4096
    buffer_load_dwordx4 v[100:103], v1, s[28:31], s40 offen offset:0 nt
    v_add_f32_dpp v52, v52, v52 row_ror:8 row_mask:0xf bank_mask:0xf
    v_add_f32_dpp v53, v53, v53 row_ror:8 row_mask:0xf bank_mask:0xf
    v_add_f32_dpp v54, v54, v54 row_ror:8 row_mask:0xf bank_mask:0xf
    v_add_f32_dpp v55, v55, v55 row_ror:8 row_mask:0xf bank_mask:0xf
    v_add_f32_dpp v52, v52, v52 row_ror:4 row_mask:0xf bank_mask:0xf
    v_add_f32_dpp v53, v53, v53 row_ror:4 row_mask:0xf bank_mask:0xf
    v_add_f32_dpp v54, v54, v54 row_ror:4 row_mask:0xf bank_mask:0xf
    v_add_f32_dpp v55, v55, v55 row_ror:4 row_mask:0xf bank_mask:0xf
    v_add_f32_dpp v52, v52, v52 row_ror:2 row_mask:0xf bank_mask:0xf
    v_add_f32_dpp v53, v53, v53 row_ror:2 row_mask:0xf bank_mask:0xf
    v_add_f32_dpp v54, v54, v54 row_ror:2 row_mask:0xf bank_mask:0xf
    v_add_f32_dpp v55, v55, v55 row_ror:2 row_mask:0xf bank_mask:0xf
    v_add_f32_dpp v52, v52, v52 row_ror:1 row_mask:0xf bank_mask:0xf
    v_add_f32_dpp v53, v53, v53 row_ror:1 row_mask:0xf bank_mask:0xf
    v_add_f32_dpp v54, v54, v54 row_ror:1 row_mask:0xf bank_mask:0xf
    v_add_f32_dpp v55, v55, v55 row_ror:1 row_mask:0xf bank_mask:0xf
    s_waitcnt vmcnt(15)
    v_dot2_f32_bf16 v57, v104, v4, 0
    v_dot2_f32_bf16 v57, v105, v5, v57
    v_dot2_f32_bf16 v57, v106, v6, v57
    v_dot2_f32_bf16 v57, v107, v7, v57
    s_mov_b32 s41, 4096
    buffer_load_dwordx4 v[104:107], v1, s[28:31], s41 offen offset:1024 nt
    s_waitcnt vmcnt(15)
    v_dot2_f32_bf16 v58, v108, v4, 0
    v_dot2_f32_bf16 v58, v109, v5, v58
    v_dot2_f32_bf16 v58, v110, v6, v58
    v_dot2_f32_bf16 v58, v111, v7, v58
    s_mov_b32 s42, 4096
    buffer_load_dwordx4 v[108:111], v1, s[28:31], s42 offen offset:2048 nt
    s_waitcnt vmcnt(15)
    v_dot2_f32_bf16 v59, v112, v4, 0
    v_dot2_f32_bf16 v59, v113, v5, v59
    v_dot2_f32_bf16 v59, v114, v6, v59
    v_dot2_f32_bf16 v59, v115, v7, v59
    s_mov_b32 s43, 4096
    buffer_load_dwordx4 v[112:115], v1, s[28:31], s43 offen offset:3072 nt
    s_waitcnt vmcnt(15)
    v_dot2_f32_bf16 v60, v116, v4, 0
    v_dot2_f32_bf16 v60, v117, v5, v60
    v_dot2_f32_bf16 v60, v118, v6, v60
    v_dot2_f32_bf16 v60, v119, v7, v60
    s_mov_b32 s44, 8192
    buffer_load_dwordx4 v[116:119], v1, s[28:31], s44 offen offset:0 nt
    v_add_f32_dpp v56, v56, v56 row_ror:8 row_mask:0xf bank_mask:0xf
    v_add_f32_dpp v57, v57, v57 row_ror:8 row_mask:0xf bank_mask:0xf
    v_add_f32_dpp v58, v58, v58 row_ror:8 row_mask:0xf bank_mask:0xf
    v_add_f32_dpp v59, v59, v59 row_ror:8 row_mask:0xf bank_mask:0xf
    v_add_f32_dpp v56, v56, v56 row_ror:4 row_mask:0xf bank_mask:0xf
    v_add_f32_dpp v57, v57, v57 row_ror:4 row_mask:0xf bank_mask:0xf
    v_add_f32_dpp v58, v58, v58 row_ror:4 row_mask:0xf bank_mask:0xf
    v_add_f32_dpp v59, v59, v59 row_ror:4 row_mask:0xf bank_mask:0xf
    v_add_f32_dpp v56, v56, v56 row_ror:2 row_mask:0xf bank_mask:0xf
    v_add_f32_dpp v57, v57, v57 row_ror:2 row_mask:0xf bank_mask:0xf
    v_add_f32_dpp v58, v58, v58 row_ror:2 row_mask:0xf bank_mask:0xf
    v_add_f32_dpp v59, v59, v59 row_ror:2 row_mask:0xf bank_mask:0xf
    v_add_f32_dpp v56, v56, v56 row_ror:1 row_mask:0xf bank_mask:0xf
    v_add_f32_dpp v57, v57, v57 row_ror:1 row_mask:0xf bank_mask:0xf
    v_add_f32_dpp v58, v58, v58 row_ror:1 row_mask:0xf bank_mask:0xf
    v_add_f32_dpp v59, v59, v59 row_ror:1 row_mask:0xf bank_mask:0xf
    s_waitcnt vmcnt(15)
    v_dot2_f32_bf16 v61, v120, v4, 0
    v_dot2_f32_bf16 v61, v121, v5, v61
    v_dot2_f32_bf16 v61, v122, v6, v61
    v_dot2_f32_bf16 v61, v123, v7, v61
    s_mov_b32 s45, 8192
    buffer_load_dwordx4 v[120:123], v1, s[28:31], s45 offen offset:1024 nt
    s_waitcnt vmcnt(15)
    v_dot2_f32_bf16 v62, v124, v4, 0
    v_dot2_f32_bf16 v62, v125, v5, v62
    v_dot2_f32_bf16 v62, v126, v6, v62
    v_dot2_f32_bf16 v62, v127, v7, v62
    s_mov_b32 s46, 8192
    buffer_load_dwordx4 v[124:127], v1, s[28:31], s46 offen offset:2048 nt
    s_waitcnt vmcnt(15)
    v_dot2_f32_bf16 v63, v128, v4, 0
    v_dot2_f32_bf16 v63, v129, v5, v63
    v_dot2_f32_bf16 v63, v130, v6, v63
    v_dot2_f32_bf16 v63, v131, v7, v63
    s_mov_b32 s47, 8192
    buffer_load_dwordx4 v[128:131], v1, s[28:31], s47 offen offset:3072 nt
    s_waitcnt vmcnt(15)
    v_dot2_f32_bf16 v64, v132, v4, 0
    v_dot2_f32_bf16 v64, v133, v5, v64
    v_dot2_f32_bf16 v64, v134, v6, v64
    v_dot2_f32_bf16 v64, v135, v7, v64
    s_mov_b32 s40, 12288
    buffer_load_dwordx4 v[132:135], v1, s[28:31], s40 offen offset:0 nt
    v_add_f32_dpp v60, v60, v60 row_ror:8 row_mask:0xf bank_mask:0xf
    v_add_f32_dpp v61, v61, v61 row_ror:8 row_mask:0xf bank_mask:0xf
    v_add_f32_dpp v62, v62, v62 row_ror:8 row_mask:0xf bank_mask:0xf
    v_add_f32_dpp v63, v63, v63 row_ror:8 row_mask:0xf bank_mask:0xf
    v_add_f32_dpp v60, v60, v60 row_ror:4 row_mask:0xf bank_mask:0xf
    v_add_f32_dpp v61, v61, v61 row_ror:4 row_mask:0xf bank_mask:0xf
    v_add_f32_dpp v62, v62, v62 row_ror:4 row_mask:0xf bank_mask:0xf
    v_add_f32_dpp v63, v63, v63 row_ror:4 row_mask:0xf bank_mask:0xf
    v_add_f32_dpp v60, v60, v60 row_ror:2 row_mask:0xf bank_mask:0xf
    v_add_f32_dpp v61, v61, v61 row_ror:2 row_mask:0xf bank_mask:0xf
    v_add_f32_dpp v62, v62, v62 row_ror:2 row_mask:0xf bank_mask:0xf
    v_add_f32_dpp v63, v63, v63 row_ror:2 row_mask:0xf bank_mask:0xf
    v_add_f32_dpp v60, v60, v60 row_ror:1 row_mask:0xf bank_mask:0xf
    v_add_f32_dpp v61, v61, v61 row_ror:1 row_mask:0xf bank_mask:0xf
    v_add_f32_dpp v62, v62, v62 row_ror:1 row_mask:0xf bank_mask:0xf
    v_add_f32_dpp v63, v63, v63 row_ror:1 row_mask:0xf bank_mask:0xf
    s_waitcnt vmcnt(15)
    v_dot2_f32_bf16 v65, v136, v4, 0
    v_dot2_f32_bf16 v65, v137, v5, v65
    v_dot2_f32_bf16 v65, v138, v6, v65
    v_dot2_f32_bf16 v65, v139, v7, v65
    s_mov_b32 s41, 12288
    buffer_load_dwordx4 v[136:139], v1, s[28:31], s41 offen offset:1024 nt
    s_waitcnt vmcnt(15)
    v_dot2_f32_bf16 v66, v140, v4, 0
    v_dot2_f32_bf16 v66, v141, v5, v66
    v_dot2_f32_bf16 v66, v142, v6, v66
    v_dot2_f32_bf16 v66, v143, v7, v66
    s_mov_b32 s42, 12288
    buffer_load_dwordx4 v[140:143], v1, s[28:31], s42 offen offset:2048 nt
    s_waitcnt vmcnt(15)
    v_dot2_f32_bf16 v67, v144, v4, 0
    v_dot2_f32_bf16 v67, v145, v5, v67
    v_dot2_f32_bf16 v67, v146, v6, v67
    v_dot2_f32_bf16 v67, v147, v7, v67
    s_mov_b32 s43, 12288
    buffer_load_dwordx4 v[144:147], v1, s[28:31], s43 offen offset:3072 nt
    s_nop 3
    v_add_f32_dpp v64, v64, v64 row_ror:8 row_mask:0xf bank_mask:0xf
    v_add_f32_dpp v65, v65, v65 row_ror:8 row_mask:0xf bank_mask:0xf
    v_add_f32_dpp v66, v66, v66 row_ror:8 row_mask:0xf bank_mask:0xf
    v_add_f32_dpp v67, v67, v67 row_ror:8 row_mask:0xf bank_mask:0xf
    v_add_f32_dpp v64, v64, v64 row_ror:4 row_mask:0xf bank_mask:0xf
    v_add_f32_dpp v65, v65, v65 row_ror:4 row_mask:0xf bank_mask:0xf
    v_add_f32_dpp v66, v66, v66 row_ror:4 row_mask:0xf bank_mask:0xf
    v_add_f32_dpp v67, v67, v67 row_ror:4 row_mask:0xf bank_mask:0xf
    v_add_f32_dpp v64, v64, v64 row_ror:2 row_mask:0xf bank_mask:0xf
    v_add_f32_dpp v65, v65, v65 row_ror:2 row_mask:0xf bank_mask:0xf
    v_add_f32_dpp v66, v66, v66 row_ror:2 row_mask:0xf bank_mask:0xf
    v_add_f32_dpp v67, v67, v67 row_ror:2 row_mask:0xf bank_mask:0xf
    v_add_f32_dpp v64, v64, v64 row_ror:1 row_mask:0xf bank_mask:0xf
    v_add_f32_dpp v65, v65, v65 row_ror:1 row_mask:0xf bank_mask:0xf
    v_add_f32_dpp v66, v66, v66 row_ror:1 row_mask:0xf bank_mask:0xf
    v_add_f32_dpp v67, v67, v67 row_ror:1 row_mask:0xf bank_mask:0xf
    v_max3_f32 v92, v8, v9, v10
    v_max3_f32 v92, v92, v11, v12
    v_max3_f32 v92, v92, v13, v14
    v_max3_f32 v92, v92, v15, v16
    v_max3_f32 v92, v92, v17, v18
    v_max3_f32 v92, v92, v19, v20
    v_max3_f32 v92, v92, v21, v22
    v_max3_f32 v92, v92, v23, v24
    v_max3_f32 v92, v92, v25, v26
    v_max3_f32 v92, v92, v27, v28
    v_max3_f32 v92, v92, v29, v30
    v_max3_f32 v92, v92, v31, v32
    v_max3_f32 v92, v92, v33, v34
    v_max3_f32 v92, v92, v35, v36
    v_max3_f32 v92, v92, v37, v38
    v_max3_f32 v92, v92, v39, v40
    v_max3_f32 v92, v92, v41, v42
    v_max3_f32 v92, v92, v43, v44
    v_max3_f32 v92, v92, v45, v46
    v_max3_f32 v92, v92, v47, v48
    v_max3_f32 v92, v92, v49, v50
    v_max3_f32 v92, v92, v51, v52
    v_max3_f32 v92, v92, v53, v54
    v_max3_f32 v92, v92, v55, v56
    v_max3_f32 v92, v92, v57, v58
    v_max3_f32 v92, v92, v59, v60
    v_max3_f32 v92, v92, v61, v62
    v_max3_f32 v92, v92, v63, v64
    v_max3_f32 v92, v92, v65, v66
    v_max_f32 v92, v92, v67
    v_mov_b32 v93, v92
    s_nop 1
    v_permlane32_swap_b32 v92, v93
    s_nop 1
    v_max_f32 v92, v92, v93
    v_mov_b32 v93, v92
    s_nop 1
    v_permlane16_swap_b32 v92, v93
    s_nop 1
    v_max_f32 v92, v92, v93
    v_mul_f32 v93, s60, v92
    v_fma_f32 v8, v8, s60, -v93
    v_fma_f32 v9, v9, s60, -v93
    v_fma_f32 v10, v10, s60, -v93
    v_fma_f32 v11, v11, s60, -v93
    v_fma_f32 v12, v12, s60, -v93
    v_fma_f32 v13, v13, s60, -v93
    v_fma_f32 v14, v14, s60, -v93
    v_fma_f32 v15, v15, s60, -v93
    v_fma_f32 v16, v16, s60, -v93
    v_fma_f32 v17, v17, s60, -v93
    v_fma_f32 v18, v18, s60, -v93
    v_fma_f32 v19, v19, s60, -v93
    v_fma_f32 v20, v20, s60, -v93
    v_fma_f32 v21, v21, s60, -v93
    v_fma_f32 v22, v22, s60, -v93
    v_fma_f32 v23, v23, s60, -v93
    v_fma_f32 v24, v24, s60, -v93
    v_fma_f32 v25, v25, s60, -v93
    v_fma_f32 v26, v26, s60, -v93
    v_fma_f32 v27, v27, s60, -v93
    v_fma_f32 v28, v28, s60, -v93
    v_fma_f32 v29, v29, s60, -v93
    v_fma_f32 v30, v30, s60, -v93
    v_fma_f32 v31, v31, s60, -v93
    v_fma_f32 v32, v32, s60, -v93
    v_fma_f32 v33, v33, s60, -v93
    v_fma_f32 v34, v34, s60, -v93
    v_fma_f32 v35, v35, s60, -v93
    v_fma_f32 v36, v36, s60, -v93
    v_fma_f32 v37, v37, s60, -v93
    v_fma_f32 v38, v38, s60, -v93
    v_fma_f32 v39, v39, s60, -v93
    v_fma_f32 v40, v40, s60, -v93
    v_fma_f32 v41, v41, s60, -v93
    v_fma_f32 v42, v42, s60, -v93
    v_fma_f32 v43, v43, s60, -v93
    v_fma_f32 v44, v44, s60, -v93
    v_fma_f32 v45, v45, s60, -v93
    v_fma_f32 v46, v46, s60, -v93
    v_fma_f32 v47, v47, s60, -v93
    v_fma_f32 v48, v48, s60, -v93
    v_fma_f32 v49, v49, s60, -v93
    v_fma_f32 v50, v50, s60, -v93
    v_fma_f32 v51, v51, s60, -v93
    v_fma_f32 v52, v52, s60, -v93
    v_fma_f32 v53, v53, s60, -v93
    v_fma_f32 v54, v54, s60, -v93
    v_fma_f32 v55, v55, s60, -v93
    v_fma_f32 v56, v56, s60, -v93
    v_fma_f32 v57, v57, s60, -v93
    v_fma_f32 v58, v58, s60, -v93
    v_fma_f32 v59, v59, s60, -v93
    v_fma_f32 v60, v60, s60, -v93
    v_fma_f32 v61, v61, s60, -v93
    v_fma_f32 v62, v62, s60, -v93
    v_fma_f32 v63, v63, s60, -v93
    v_fma_f32 v64, v64, s60, -v93
    v_fma_f32 v65, v65, s60, -v93
    v_fma_f32 v66, v66, s60, -v93
    v_fma_f32 v67, v67, s60, -v93
    v_exp_f32 v8, v8
    v_exp_f32 v9, v9
    v_exp_f32 v10, v10
    v_exp_f32 v11, v11
    v_exp_f32 v12, v12
    v_exp_f32 v13, v13
    v_exp_f32 v14, v14
    v_exp_f32 v15, v15
    v_exp_f32 v16, v16
    v_exp_f32 v17, v17
    v_exp_f32 v18, v18
    v_exp_f32 v19, v19
    v_exp_f32 v20, v20
    v_exp_f32 v21, v21
    v_exp_f32 v22, v22
    v_exp_f32 v23, v23
    v_exp_f32 v24, v24
    v_exp_f32 v25, v25
    v_exp_f32 v26, v26
    v_exp_f32 v27, v27
    v_exp_f32 v28, v28
    v_exp_f32 v29, v29
    v_exp_f32 v30, v30
    v_exp_f32 v31, v31
    v_exp_f32 v32, v32
    v_exp_f32 v33, v33
    v_exp_f32 v34, v34
    v_exp_f32 v35, v35
    v_exp_f32 v36, v36
    v_exp_f32 v37, v37
    v_exp_f32 v38, v38
    v_exp_f32 v39, v39
    v_exp_f32 v40, v40
    v_exp_f32 v41, v41
    v_exp_f32 v42, v42
    v_exp_f32 v43, v43
    v_exp_f32 v44, v44
    v_exp_f32 v45, v45
    v_exp_f32 v46, v46
    v_exp_f32 v47, v47
    v_exp_f32 v48, v48
    v_exp_f32 v49, v49
    v_exp_f32 v50, v50
    v_exp_f32 v51, v51
    v_exp_f32 v52, v52
    v_exp_f32 v53, v53
    v_exp_f32 v54, v54
    v_exp_f32 v55, v55
    v_exp_f32 v56, v56
    v_exp_f32 v57, v57
    v_exp_f32 v58, v58
    v_exp_f32 v59, v59
    v_exp_f32 v60, v60
    v_exp_f32 v61, v61
    v_exp_f32 v62, v62
    v_exp_f32 v63, v63
    v_exp_f32 v64, v64
    v_exp_f32 v65, v65
    v_exp_f32 v66, v66
    v_exp_f32 v67, v67
    s_nop 0
    v_add_f32 v94, v8, v9
    v_add_f32 v95, v10, v11
    v_add_f32 v94, v94, v12
    v_add_f32 v95, v95, v13
    v_add_f32 v94, v94, v14
    v_add_f32 v95, v95, v15
    v_add_f32 v94, v94, v16
    v_add_f32 v95, v95, v17
    v_add_f32 v94, v94, v18
    v_add_f32 v95, v95, v19
    v_add_f32 v94, v94, v20
    v_add_f32 v95, v95, v21
    v_add_f32 v94, v94, v22
    v_add_f32 v95, v95, v23
    v_add_f32 v94, v94, v24
    v_add_f32 v95, v95, v25
    v_add_f32 v94, v94, v26
    v_add_f32 v95, v95, v27
    v_add_f32 v94, v94, v28
    v_add_f32 v95, v95, v29
    v_add_f32 v94, v94, v30
    v_add_f32 v95, v95, v31
    v_add_f32 v94, v94, v32
    v_add_f32 v95, v95, v33
    v_add_f32 v94, v94, v34
    v_add_f32 v95, v95, v35
    v_add_f32 v94, v94, v36
    v_add_f32 v95, v95, v37
    v_add_f32 v94, v94, v38
    v_add_f32 v95, v95, v39
    v_add_f32 v94, v94, v40
    v_add_f32 v95, v95, v41
    v_add_f32 v94, v94, v42
    v_add_f32 v95, v95, v43
    v_add_f32 v94, v94, v44
    v_add_f32 v95, v95, v45
    v_add_f32 v94, v94, v46
    v_add_f32 v95, v95, v47
    v_add_f32 v94, v94, v48
    v_add_f32 v95, v95, v49
    v_add_f32 v94, v94, v50
    v_add_f32 v95, v95, v51
    v_add_f32 v94, v94, v52
    v_add_f32 v95, v95, v53
    v_add_f32 v94, v94, v54
    v_add_f32 v95, v95, v55
    v_add_f32 v94, v94, v56
    v_add_f32 v95, v95, v57
    v_add_f32 v94, v94, v58
    v_add_f32 v95, v95, v59
    v_add_f32 v94, v94, v60
    v_add_f32 v95, v95, v61
    v_add_f32 v94, v94, v62
    v_add_f32 v95, v95, v63
    v_add_f32 v94, v94, v64
    v_add_f32 v95, v95, v65
    v_add_f32 v94, v94, v66
    v_add_f32 v95, v95, v67
    v_add_f32 v94, v94, v95
    s_waitcnt vmcnt(15)
    v_lshlrev_b32 v84, 16, v148
    v_and_b32 v85, s61, v148
    v_lshlrev_b32 v86, 16, v149
    v_and_b32 v87, s61, v149
    v_lshlrev_b32 v88, 16, v150
    v_and_b32 v89, s61, v150
    v_lshlrev_b32 v90, 16, v151
    v_and_b32 v91, s61, v151
    s_mov_b32 s44, 16384
    buffer_load_dwordx4 v[148:151], v1, s[28:31], s44 offen offset:0 nt
    v_fmac_f32 v76, v8, v84
    v_fmac_f32 v77, v8, v85
    v_fmac_f32 v78, v8, v86
    v_fmac_f32 v79, v8, v87
    v_fmac_f32 v80, v8, v88
    v_fmac_f32 v81, v8, v89
    v_fmac_f32 v82, v8, v90
    v_fmac_f32 v83, v8, v91
    s_waitcnt vmcnt(15)
    v_lshlrev_b32 v84, 16, v152
    v_and_b32 v85, s61, v152
    v_lshlrev_b32 v86, 16, v153
    v_and_b32 v87, s61, v153
    v_lshlrev_b32 v88, 16, v154
    v_and_b32 v89, s61, v154
    v_lshlrev_b32 v90, 16, v155
    v_and_b32 v91, s61, v155
    s_mov_b32 s45, 16384
    buffer_load_dwordx4 v[152:155], v1, s[28:31], s45 offen offset:1024 nt
    v_fmac_f32 v76, v9, v84
    v_fmac_f32 v77, v9, v85
    v_fmac_f32 v78, v9, v86
    v_fmac_f32 v79, v9, v87
    v_fmac_f32 v80, v9, v88
    v_fmac_f32 v81, v9, v89
    v_fmac_f32 v82, v9, v90
    v_fmac_f32 v83, v9, v91
    s_waitcnt vmcnt(15)
    v_lshlrev_b32 v84, 16, v156
    v_and_b32 v85, s61, v156
    v_lshlrev_b32 v86, 16, v157
    v_and_b32 v87, s61, v157
    v_lshlrev_b32 v88, 16, v158
    v_and_b32 v89, s61, v158
    v_lshlrev_b32 v90, 16, v159
    v_and_b32 v91, s61, v159
    s_mov_b32 s46, 16384
    buffer_load_dwordx4 v[156:159], v1, s[28:31], s46 offen offset:2048 nt
    v_fmac_f32 v76, v10, v84
    v_fmac_f32 v77, v10, v85
    v_fmac_f32 v78, v10, v86
    v_fmac_f32 v79, v10, v87
    v_fmac_f32 v80, v10, v88
    v_fmac_f32 v81, v10, v89
    v_fmac_f32 v82, v10, v90
    v_fmac_f32 v83, v10, v91
    s_waitcnt vmcnt(15)
    v_lshlrev_b32 v84, 16, v160
    v_and_b32 v85, s61, v160
    v_lshlrev_b32 v86, 16, v161
    v_and_b32 v87, s61, v161
    v_lshlrev_b32 v88, 16, v162
    v_and_b32 v89, s61, v162
    v_lshlrev_b32 v90, 16, v163
    v_and_b32 v91, s61, v163
    s_mov_b32 s47, 16384
    buffer_load_dwordx4 v[160:163], v1, s[28:31], s47 offen offset:3072 nt
    v_fmac_f32 v76, v11, v84
    v_fmac_f32 v77, v11, v85
    v_fmac_f32 v78, v11, v86
    v_fmac_f32 v79, v11, v87
    v_fmac_f32 v80, v11, v88
    v_fmac_f32 v81, v11, v89
    v_fmac_f32 v82, v11, v90
    v_fmac_f32 v83, v11, v91
    s_waitcnt vmcnt(15)
    v_lshlrev_b32 v84, 16, v100
    v_and_b32 v85, s61, v100
    v_lshlrev_b32 v86, 16, v101
    v_and_b32 v87, s61, v101
    v_lshlrev_b32 v88, 16, v102
    v_and_b32 v89, s61, v102
    v_lshlrev_b32 v90, 16, v103
    v_and_b32 v91, s61, v103
    s_mov_b32 s40, 20480
    buffer_load_dwordx4 v[100:103], v1, s[28:31], s40 offen offset:0 nt
    v_fmac_f32 v76, v12, v84
    v_fmac_f32 v77, v12, v85
    v_fmac_f32 v78, v12, v86
    v_fmac_f32 v79, v12, v87
    v_fmac_f32 v80, v12, v88
    v_fmac_f32 v81, v12, v89
    v_fmac_f32 v82, v12, v90
    v_fmac_f32 v83, v12, v91
    s_waitcnt vmcnt(15)
    v_lshlrev_b32 v84, 16, v104
    v_and_b32 v85, s61, v104
    v_lshlrev_b32 v86, 16, v105
    v_and_b32 v87, s61, v105
    v_lshlrev_b32 v88, 16, v106
    v_and_b32 v89, s61, v106
    v_lshlrev_b32 v90, 16, v107
    v_and_b32 v91, s61, v107
    s_mov_b32 s41, 20480
    buffer_load_dwordx4 v[104:107], v1, s[28:31], s41 offen offset:1024 nt
    v_fmac_f32 v76, v13, v84
    v_fmac_f32 v77, v13, v85
    v_fmac_f32 v78, v13, v86
    v_fmac_f32 v79, v13, v87
    v_fmac_f32 v80, v13, v88
    v_fmac_f32 v81, v13, v89
    v_fmac_f32 v82, v13, v90
    v_fmac_f32 v83, v13, v91
    s_waitcnt vmcnt(15)
    v_lshlrev_b32 v84, 16, v108
    v_and_b32 v85, s61, v108
    v_lshlrev_b32 v86, 16, v109
    v_and_b32 v87, s61, v109
    v_lshlrev_b32 v88, 16, v110
    v_and_b32 v89, s61, v110
    v_lshlrev_b32 v90, 16, v111
    v_and_b32 v91, s61, v111
    s_mov_b32 s42, 20480
    buffer_load_dwordx4 v[108:111], v1, s[28:31], s42 offen offset:2048 nt
    v_fmac_f32 v76, v14, v84
    v_fmac_f32 v77, v14, v85
    v_fmac_f32 v78, v14, v86
    v_fmac_f32 v79, v14, v87
    v_fmac_f32 v80, v14, v88
    v_fmac_f32 v81, v14, v89
    v_fmac_f32 v82, v14, v90
    v_fmac_f32 v83, v14, v91
    s_waitcnt vmcnt(15)
    v_lshlrev_b32 v84, 16, v112
    v_and_b32 v85, s61, v112
    v_lshlrev_b32 v86, 16, v113
    v_and_b32 v87, s61, v113
    v_lshlrev_b32 v88, 16, v114
    v_and_b32 v89, s61, v114
    v_lshlrev_b32 v90, 16, v115
    v_and_b32 v91, s61, v115
    s_mov_b32 s43, 20480
    buffer_load_dwordx4 v[112:115], v1, s[28:31], s43 offen offset:3072 nt
    v_fmac_f32 v76, v15, v84
    v_fmac_f32 v77, v15, v85
    v_fmac_f32 v78, v15, v86
    v_fmac_f32 v79, v15, v87
    v_fmac_f32 v80, v15, v88
    v_fmac_f32 v81, v15, v89
    v_fmac_f32 v82, v15, v90
    v_fmac_f32 v83, v15, v91
    s_waitcnt vmcnt(15)
    v_lshlrev_b32 v84, 16, v116
    v_and_b32 v85, s61, v116
    v_lshlrev_b32 v86, 16, v117
    v_and_b32 v87, s61, v117
    v_lshlrev_b32 v88, 16, v118
    v_and_b32 v89, s61, v118
    v_lshlrev_b32 v90, 16, v119
    v_and_b32 v91, s61, v119
    s_mov_b32 s44, 24576
    buffer_load_dwordx4 v[116:119], v1, s[28:31], s44 offen offset:0 nt
    v_fmac_f32 v76, v16, v84
    v_fmac_f32 v77, v16, v85
    v_fmac_f32 v78, v16, v86
    v_fmac_f32 v79, v16, v87
    v_fmac_f32 v80, v16, v88
    v_fmac_f32 v81, v16, v89
    v_fmac_f32 v82, v16, v90
    v_fmac_f32 v83, v16, v91
    s_waitcnt vmcnt(15)
    v_lshlrev_b32 v84, 16, v120
    v_and_b32 v85, s61, v120
    v_lshlrev_b32 v86, 16, v121
    v_and_b32 v87, s61, v121
    v_lshlrev_b32 v88, 16, v122
    v_and_b32 v89, s61, v122
    v_lshlrev_b32 v90, 16, v123
    v_and_b32 v91, s61, v123
    s_mov_b32 s45, 24576
    buffer_load_dwordx4 v[120:123], v1, s[28:31], s45 offen offset:1024 nt
    v_fmac_f32 v76, v17, v84
    v_fmac_f32 v77, v17, v85
    v_fmac_f32 v78, v17, v86
    v_fmac_f32 v79, v17, v87
    v_fmac_f32 v80, v17, v88
    v_fmac_f32 v81, v17, v89
    v_fmac_f32 v82, v17, v90
    v_fmac_f32 v83, v17, v91
    s_waitcnt vmcnt(15)
    v_lshlrev_b32 v84, 16, v124
    v_and_b32 v85, s61, v124
    v_lshlrev_b32 v86, 16, v125
    v_and_b32 v87, s61, v125
    v_lshlrev_b32 v88, 16, v126
    v_and_b32 v89, s61, v126
    v_lshlrev_b32 v90, 16, v127
    v_and_b32 v91, s61, v127
    s_mov_b32 s46, 24576
    buffer_load_dwordx4 v[124:127], v1, s[28:31], s46 offen offset:2048 nt
    v_fmac_f32 v76, v18, v84
    v_fmac_f32 v77, v18, v85
    v_fmac_f32 v78, v18, v86
    v_fmac_f32 v79, v18, v87
    v_fmac_f32 v80, v18, v88
    v_fmac_f32 v81, v18, v89
    v_fmac_f32 v82, v18, v90
    v_fmac_f32 v83, v18, v91
    s_waitcnt vmcnt(15)
    v_lshlrev_b32 v84, 16, v128
    v_and_b32 v85, s61, v128
    v_lshlrev_b32 v86, 16, v129
    v_and_b32 v87, s61, v129
    v_lshlrev_b32 v88, 16, v130
    v_and_b32 v89, s61, v130
    v_lshlrev_b32 v90, 16, v131
    v_and_b32 v91, s61, v131
    s_mov_b32 s47, 24576
    buffer_load_dwordx4 v[128:131], v1, s[28:31], s47 offen offset:3072 nt
    v_fmac_f32 v76, v19, v84
    v_fmac_f32 v77, v19, v85
    v_fmac_f32 v78, v19, v86
    v_fmac_f32 v79, v19, v87
    v_fmac_f32 v80, v19, v88
    v_fmac_f32 v81, v19, v89
    v_fmac_f32 v82, v19, v90
    v_fmac_f32 v83, v19, v91
    s_waitcnt vmcnt(15)
    v_lshlrev_b32 v84, 16, v132
    v_and_b32 v85, s61, v132
    v_lshlrev_b32 v86, 16, v133
    v_and_b32 v87, s61, v133
    v_lshlrev_b32 v88, 16, v134
    v_and_b32 v89, s61, v134
    v_lshlrev_b32 v90, 16, v135
    v_and_b32 v91, s61, v135
    s_mov_b32 s40, 28672
    buffer_load_dwordx4 v[132:135], v1, s[28:31], s40 offen offset:0 nt
    v_fmac_f32 v76, v20, v84
    v_fmac_f32 v77, v20, v85
    v_fmac_f32 v78, v20, v86
    v_fmac_f32 v79, v20, v87
    v_fmac_f32 v80, v20, v88
    v_fmac_f32 v81, v20, v89
    v_fmac_f32 v82, v20, v90
    v_fmac_f32 v83, v20, v91
    s_waitcnt vmcnt(15)
    v_lshlrev_b32 v84, 16, v136
    v_and_b32 v85, s61, v136
    v_lshlrev_b32 v86, 16, v137
    v_and_b32 v87, s61, v137
    v_lshlrev_b32 v88, 16, v138
    v_and_b32 v89, s61, v138
    v_lshlrev_b32 v90, 16, v139
    v_and_b32 v91, s61, v139
    s_mov_b32 s41, 28672
    buffer_load_dwordx4 v[136:139], v1, s[28:31], s41 offen offset:1024 nt
    v_fmac_f32 v76, v21, v84
    v_fmac_f32 v77, v21, v85
    v_fmac_f32 v78, v21, v86
    v_fmac_f32 v79, v21, v87
    v_fmac_f32 v80, v21, v88
    v_fmac_f32 v81, v21, v89
    v_fmac_f32 v82, v21, v90
    v_fmac_f32 v83, v21, v91
    s_waitcnt vmcnt(15)
    v_lshlrev_b32 v84, 16, v140
    v_and_b32 v85, s61, v140
    v_lshlrev_b32 v86, 16, v141
    v_and_b32 v87, s61, v141
    v_lshlrev_b32 v88, 16, v142
    v_and_b32 v89, s61, v142
    v_lshlrev_b32 v90, 16, v143
    v_and_b32 v91, s61, v143
    s_mov_b32 s42, 28672
    buffer_load_dwordx4 v[140:143], v1, s[28:31], s42 offen offset:2048 nt
    v_fmac_f32 v76, v22, v84
    v_fmac_f32 v77, v22, v85
    v_fmac_f32 v78, v22, v86
    v_fmac_f32 v79, v22, v87
    v_fmac_f32 v80, v22, v88
    v_fmac_f32 v81, v22, v89
    v_fmac_f32 v82, v22, v90
    v_fmac_f32 v83, v22, v91
    s_waitcnt vmcnt(15)
    v_lshlrev_b32 v84, 16, v144
    v_and_b32 v85, s61, v144
    v_lshlrev_b32 v86, 16, v145
    v_and_b32 v87, s61, v145
    v_lshlrev_b32 v88, 16, v146
    v_and_b32 v89, s61, v146
    v_lshlrev_b32 v90, 16, v147
    v_and_b32 v91, s61, v147
    s_mov_b32 s43, 28672
    buffer_load_dwordx4 v[144:147], v1, s[28:31], s43 offen offset:3072 nt
    v_fmac_f32 v76, v23, v84
    v_fmac_f32 v77, v23, v85
    v_fmac_f32 v78, v23, v86
    v_fmac_f32 v79, v23, v87
    v_fmac_f32 v80, v23, v88
    v_fmac_f32 v81, v23, v89
    v_fmac_f32 v82, v23, v90
    v_fmac_f32 v83, v23, v91
    s_waitcnt vmcnt(15)
    v_lshlrev_b32 v84, 16, v148
    v_and_b32 v85, s61, v148
    v_lshlrev_b32 v86, 16, v149
    v_and_b32 v87, s61, v149
    v_lshlrev_b32 v88, 16, v150
    v_and_b32 v89, s61, v150
    v_lshlrev_b32 v90, 16, v151
    v_and_b32 v91, s61, v151
    s_mov_b32 s44, 32768
    buffer_load_dwordx4 v[148:151], v1, s[28:31], s44 offen offset:0 nt
    v_fmac_f32 v76, v24, v84
    v_fmac_f32 v77, v24, v85
    v_fmac_f32 v78, v24, v86
    v_fmac_f32 v79, v24, v87
    v_fmac_f32 v80, v24, v88
    v_fmac_f32 v81, v24, v89
    v_fmac_f32 v82, v24, v90
    v_fmac_f32 v83, v24, v91
    s_waitcnt vmcnt(15)
    v_lshlrev_b32 v84, 16, v152
    v_and_b32 v85, s61, v152
    v_lshlrev_b32 v86, 16, v153
    v_and_b32 v87, s61, v153
    v_lshlrev_b32 v88, 16, v154
    v_and_b32 v89, s61, v154
    v_lshlrev_b32 v90, 16, v155
    v_and_b32 v91, s61, v155
    s_mov_b32 s45, 32768
    buffer_load_dwordx4 v[152:155], v1, s[28:31], s45 offen offset:1024 nt
    v_fmac_f32 v76, v25, v84
    v_fmac_f32 v77, v25, v85
    v_fmac_f32 v78, v25, v86
    v_fmac_f32 v79, v25, v87
    v_fmac_f32 v80, v25, v88
    v_fmac_f32 v81, v25, v89
    v_fmac_f32 v82, v25, v90
    v_fmac_f32 v83, v25, v91
    s_waitcnt vmcnt(15)
    v_lshlrev_b32 v84, 16, v156
    v_and_b32 v85, s61, v156
    v_lshlrev_b32 v86, 16, v157
    v_and_b32 v87, s61, v157
    v_lshlrev_b32 v88, 16, v158
    v_and_b32 v89, s61, v158
    v_lshlrev_b32 v90, 16, v159
    v_and_b32 v91, s61, v159
    s_mov_b32 s46, 32768
    buffer_load_dwordx4 v[156:159], v1, s[28:31], s46 offen offset:2048 nt
    v_fmac_f32 v76, v26, v84
    v_fmac_f32 v77, v26, v85
    v_fmac_f32 v78, v26, v86
    v_fmac_f32 v79, v26, v87
    v_fmac_f32 v80, v26, v88
    v_fmac_f32 v81, v26, v89
    v_fmac_f32 v82, v26, v90
    v_fmac_f32 v83, v26, v91
    s_waitcnt vmcnt(15)
    v_lshlrev_b32 v84, 16, v160
    v_and_b32 v85, s61, v160
    v_lshlrev_b32 v86, 16, v161
    v_and_b32 v87, s61, v161
    v_lshlrev_b32 v88, 16, v162
    v_and_b32 v89, s61, v162
    v_lshlrev_b32 v90, 16, v163
    v_and_b32 v91, s61, v163
    s_mov_b32 s47, 32768
    buffer_load_dwordx4 v[160:163], v1, s[28:31], s47 offen offset:3072 nt
    v_fmac_f32 v76, v27, v84
    v_fmac_f32 v77, v27, v85
    v_fmac_f32 v78, v27, v86
    v_fmac_f32 v79, v27, v87
    v_fmac_f32 v80, v27, v88
    v_fmac_f32 v81, v27, v89
    v_fmac_f32 v82, v27, v90
    v_fmac_f32 v83, v27, v91
    s_waitcnt vmcnt(15)
    v_lshlrev_b32 v84, 16, v100
    v_and_b32 v85, s61, v100
    v_lshlrev_b32 v86, 16, v101
    v_and_b32 v87, s61, v101
    v_lshlrev_b32 v88, 16, v102
    v_and_b32 v89, s61, v102
    v_lshlrev_b32 v90, 16, v103
    v_and_b32 v91, s61, v103
    s_mov_b32 s40, 36864
    buffer_load_dwordx4 v[100:103], v1, s[28:31], s40 offen offset:0 nt
    v_fmac_f32 v76, v28, v84
    v_fmac_f32 v77, v28, v85
    v_fmac_f32 v78, v28, v86
    v_fmac_f32 v79, v28, v87
    v_fmac_f32 v80, v28, v88
    v_fmac_f32 v81, v28, v89
    v_fmac_f32 v82, v28, v90
    v_fmac_f32 v83, v28, v91
    s_waitcnt vmcnt(15)
    v_lshlrev_b32 v84, 16, v104
    v_and_b32 v85, s61, v104
    v_lshlrev_b32 v86, 16, v105
    v_and_b32 v87, s61, v105
    v_lshlrev_b32 v88, 16, v106
    v_and_b32 v89, s61, v106
    v_lshlrev_b32 v90, 16, v107
    v_and_b32 v91, s61, v107
    s_mov_b32 s41, 36864
    buffer_load_dwordx4 v[104:107], v1, s[28:31], s41 offen offset:1024 nt
    v_fmac_f32 v76, v29, v84
    v_fmac_f32 v77, v29, v85
    v_fmac_f32 v78, v29, v86
    v_fmac_f32 v79, v29, v87
    v_fmac_f32 v80, v29, v88
    v_fmac_f32 v81, v29, v89
    v_fmac_f32 v82, v29, v90
    v_fmac_f32 v83, v29, v91
    s_waitcnt vmcnt(15)
    v_lshlrev_b32 v84, 16, v108
    v_and_b32 v85, s61, v108
    v_lshlrev_b32 v86, 16, v109
    v_and_b32 v87, s61, v109
    v_lshlrev_b32 v88, 16, v110
    v_and_b32 v89, s61, v110
    v_lshlrev_b32 v90, 16, v111
    v_and_b32 v91, s61, v111
    s_mov_b32 s42, 36864
    buffer_load_dwordx4 v[108:111], v1, s[28:31], s42 offen offset:2048 nt
    v_fmac_f32 v76, v30, v84
    v_fmac_f32 v77, v30, v85
    v_fmac_f32 v78, v30, v86
    v_fmac_f32 v79, v30, v87
    v_fmac_f32 v80, v30, v88
    v_fmac_f32 v81, v30, v89
    v_fmac_f32 v82, v30, v90
    v_fmac_f32 v83, v30, v91
    s_waitcnt vmcnt(15)
    v_lshlrev_b32 v84, 16, v112
    v_and_b32 v85, s61, v112
    v_lshlrev_b32 v86, 16, v113
    v_and_b32 v87, s61, v113
    v_lshlrev_b32 v88, 16, v114
    v_and_b32 v89, s61, v114
    v_lshlrev_b32 v90, 16, v115
    v_and_b32 v91, s61, v115
    s_mov_b32 s43, 36864
    buffer_load_dwordx4 v[112:115], v1, s[28:31], s43 offen offset:3072 nt
    v_fmac_f32 v76, v31, v84
    v_fmac_f32 v77, v31, v85
    v_fmac_f32 v78, v31, v86
    v_fmac_f32 v79, v31, v87
    v_fmac_f32 v80, v31, v88
    v_fmac_f32 v81, v31, v89
    v_fmac_f32 v82, v31, v90
    v_fmac_f32 v83, v31, v91
    s_waitcnt vmcnt(15)
    v_lshlrev_b32 v84, 16, v116
    v_and_b32 v85, s61, v116
    v_lshlrev_b32 v86, 16, v117
    v_and_b32 v87, s61, v117
    v_lshlrev_b32 v88, 16, v118
    v_and_b32 v89, s61, v118
    v_lshlrev_b32 v90, 16, v119
    v_and_b32 v91, s61, v119
    s_mov_b32 s44, 40960
    buffer_load_dwordx4 v[116:119], v1, s[28:31], s44 offen offset:0 nt
    v_fmac_f32 v76, v32, v84
    v_fmac_f32 v77, v32, v85
    v_fmac_f32 v78, v32, v86
    v_fmac_f32 v79, v32, v87
    v_fmac_f32 v80, v32, v88
    v_fmac_f32 v81, v32, v89
    v_fmac_f32 v82, v32, v90
    v_fmac_f32 v83, v32, v91
    s_waitcnt vmcnt(15)
    v_lshlrev_b32 v84, 16, v120
    v_and_b32 v85, s61, v120
    v_lshlrev_b32 v86, 16, v121
    v_and_b32 v87, s61, v121
    v_lshlrev_b32 v88, 16, v122
    v_and_b32 v89, s61, v122
    v_lshlrev_b32 v90, 16, v123
    v_and_b32 v91, s61, v123
    s_mov_b32 s45, 40960
    buffer_load_dwordx4 v[120:123], v1, s[28:31], s45 offen offset:1024 nt
    v_fmac_f32 v76, v33, v84
    v_fmac_f32 v77, v33, v85
    v_fmac_f32 v78, v33, v86
    v_fmac_f32 v79, v33, v87
    v_fmac_f32 v80, v33, v88
    v_fmac_f32 v81, v33, v89
    v_fmac_f32 v82, v33, v90
    v_fmac_f32 v83, v33, v91
    s_waitcnt vmcnt(15)
    v_lshlrev_b32 v84, 16, v124
    v_and_b32 v85, s61, v124
    v_lshlrev_b32 v86, 16, v125
    v_and_b32 v87, s61, v125
    v_lshlrev_b32 v88, 16, v126
    v_and_b32 v89, s61, v126
    v_lshlrev_b32 v90, 16, v127
    v_and_b32 v91, s61, v127
    s_mov_b32 s46, 40960
    buffer_load_dwordx4 v[124:127], v1, s[28:31], s46 offen offset:2048 nt
    v_fmac_f32 v76, v34, v84
    v_fmac_f32 v77, v34, v85
    v_fmac_f32 v78, v34, v86
    v_fmac_f32 v79, v34, v87
    v_fmac_f32 v80, v34, v88
    v_fmac_f32 v81, v34, v89
    v_fmac_f32 v82, v34, v90
    v_fmac_f32 v83, v34, v91
    s_waitcnt vmcnt(15)
    v_lshlrev_b32 v84, 16, v128
    v_and_b32 v85, s61, v128
    v_lshlrev_b32 v86, 16, v129
    v_and_b32 v87, s61, v129
    v_lshlrev_b32 v88, 16, v130
    v_and_b32 v89, s61, v130
    v_lshlrev_b32 v90, 16, v131
    v_and_b32 v91, s61, v131
    s_mov_b32 s47, 40960
    buffer_load_dwordx4 v[128:131], v1, s[28:31], s47 offen offset:3072 nt
    v_fmac_f32 v76, v35, v84
    v_fmac_f32 v77, v35, v85
    v_fmac_f32 v78, v35, v86
    v_fmac_f32 v79, v35, v87
    v_fmac_f32 v80, v35, v88
    v_fmac_f32 v81, v35, v89
    v_fmac_f32 v82, v35, v90
    v_fmac_f32 v83, v35, v91
    s_waitcnt vmcnt(15)
    v_lshlrev_b32 v84, 16, v132
    v_and_b32 v85, s61, v132
    v_lshlrev_b32 v86, 16, v133
    v_and_b32 v87, s61, v133
    v_lshlrev_b32 v88, 16, v134
    v_and_b32 v89, s61, v134
    v_lshlrev_b32 v90, 16, v135
    v_and_b32 v91, s61, v135
    s_mov_b32 s40, 45056
    buffer_load_dwordx4 v[132:135], v1, s[28:31], s40 offen offset:0 nt
    v_fmac_f32 v76, v36, v84
    v_fmac_f32 v77, v36, v85
    v_fmac_f32 v78, v36, v86
    v_fmac_f32 v79, v36, v87
    v_fmac_f32 v80, v36, v88
    v_fmac_f32 v81, v36, v89
    v_fmac_f32 v82, v36, v90
    v_fmac_f32 v83, v36, v91
    s_waitcnt vmcnt(15)
    v_lshlrev_b32 v84, 16, v136
    v_and_b32 v85, s61, v136
    v_lshlrev_b32 v86, 16, v137
    v_and_b32 v87, s61, v137
    v_lshlrev_b32 v88, 16, v138
    v_and_b32 v89, s61, v138
    v_lshlrev_b32 v90, 16, v139
    v_and_b32 v91, s61, v139
    s_mov_b32 s41, 45056
    buffer_load_dwordx4 v[136:139], v1, s[28:31], s41 offen offset:1024 nt
    v_fmac_f32 v76, v37, v84
    v_fmac_f32 v77, v37, v85
    v_fmac_f32 v78, v37, v86
    v_fmac_f32 v79, v37, v87
    v_fmac_f32 v80, v37, v88
    v_fmac_f32 v81, v37, v89
    v_fmac_f32 v82, v37, v90
    v_fmac_f32 v83, v37, v91
    s_waitcnt vmcnt(15)
    v_lshlrev_b32 v84, 16, v140
    v_and_b32 v85, s61, v140
    v_lshlrev_b32 v86, 16, v141
    v_and_b32 v87, s61, v141
    v_lshlrev_b32 v88, 16, v142
    v_and_b32 v89, s61, v142
    v_lshlrev_b32 v90, 16, v143
    v_and_b32 v91, s61, v143
    s_mov_b32 s42, 45056
    buffer_load_dwordx4 v[140:143], v1, s[28:31], s42 offen offset:2048 nt
    v_fmac_f32 v76, v38, v84
    v_fmac_f32 v77, v38, v85
    v_fmac_f32 v78, v38, v86
    v_fmac_f32 v79, v38, v87
    v_fmac_f32 v80, v38, v88
    v_fmac_f32 v81, v38, v89
    v_fmac_f32 v82, v38, v90
    v_fmac_f32 v83, v38, v91
    s_waitcnt vmcnt(15)
    v_lshlrev_b32 v84, 16, v144
    v_and_b32 v85, s61, v144
    v_lshlrev_b32 v86, 16, v145
    v_and_b32 v87, s61, v145
    v_lshlrev_b32 v88, 16, v146
    v_and_b32 v89, s61, v146
    v_lshlrev_b32 v90, 16, v147
    v_and_b32 v91, s61, v147
    s_mov_b32 s43, 45056
    buffer_load_dwordx4 v[144:147], v1, s[28:31], s43 offen offset:3072 nt
    v_fmac_f32 v76, v39, v84
    v_fmac_f32 v77, v39, v85
    v_fmac_f32 v78, v39, v86
    v_fmac_f32 v79, v39, v87
    v_fmac_f32 v80, v39, v88
    v_fmac_f32 v81, v39, v89
    v_fmac_f32 v82, v39, v90
    v_fmac_f32 v83, v39, v91
    s_waitcnt vmcnt(15)
    v_lshlrev_b32 v84, 16, v148
    v_and_b32 v85, s61, v148
    v_lshlrev_b32 v86, 16, v149
    v_and_b32 v87, s61, v149
    v_lshlrev_b32 v88, 16, v150
    v_and_b32 v89, s61, v150
    v_lshlrev_b32 v90, 16, v151
    v_and_b32 v91, s61, v151
    s_mov_b32 s44, 49152
    buffer_load_dwordx4 v[148:151], v1, s[28:31], s44 offen offset:0 nt
    v_fmac_f32 v76, v40, v84
    v_fmac_f32 v77, v40, v85
    v_fmac_f32 v78, v40, v86
    v_fmac_f32 v79, v40, v87
    v_fmac_f32 v80, v40, v88
    v_fmac_f32 v81, v40, v89
    v_fmac_f32 v82, v40, v90
    v_fmac_f32 v83, v40, v91
    s_waitcnt vmcnt(15)
    v_lshlrev_b32 v84, 16, v152
    v_and_b32 v85, s61, v152
    v_lshlrev_b32 v86, 16, v153
    v_and_b32 v87, s61, v153
    v_lshlrev_b32 v88, 16, v154
    v_and_b32 v89, s61, v154
    v_lshlrev_b32 v90, 16, v155
    v_and_b32 v91, s61, v155
    s_mov_b32 s45, 49152
    buffer_load_dwordx4 v[152:155], v1, s[28:31], s45 offen offset:1024 nt
    v_fmac_f32 v76, v41, v84
    v_fmac_f32 v77, v41, v85
    v_fmac_f32 v78, v41, v86
    v_fmac_f32 v79, v41, v87
    v_fmac_f32 v80, v41, v88
    v_fmac_f32 v81, v41, v89
    v_fmac_f32 v82, v41, v90
    v_fmac_f32 v83, v41, v91
    s_waitcnt vmcnt(15)
    v_lshlrev_b32 v84, 16, v156
    v_and_b32 v85, s61, v156
    v_lshlrev_b32 v86, 16, v157
    v_and_b32 v87, s61, v157
    v_lshlrev_b32 v88, 16, v158
    v_and_b32 v89, s61, v158
    v_lshlrev_b32 v90, 16, v159
    v_and_b32 v91, s61, v159
    s_mov_b32 s46, 49152
    buffer_load_dwordx4 v[156:159], v1, s[28:31], s46 offen offset:2048 nt
    v_fmac_f32 v76, v42, v84
    v_fmac_f32 v77, v42, v85
    v_fmac_f32 v78, v42, v86
    v_fmac_f32 v79, v42, v87
    v_fmac_f32 v80, v42, v88
    v_fmac_f32 v81, v42, v89
    v_fmac_f32 v82, v42, v90
    v_fmac_f32 v83, v42, v91
    s_waitcnt vmcnt(15)
    v_lshlrev_b32 v84, 16, v160
    v_and_b32 v85, s61, v160
    v_lshlrev_b32 v86, 16, v161
    v_and_b32 v87, s61, v161
    v_lshlrev_b32 v88, 16, v162
    v_and_b32 v89, s61, v162
    v_lshlrev_b32 v90, 16, v163
    v_and_b32 v91, s61, v163
    s_mov_b32 s47, 49152
    buffer_load_dwordx4 v[160:163], v1, s[28:31], s47 offen offset:3072 nt
    v_fmac_f32 v76, v43, v84
    v_fmac_f32 v77, v43, v85
    v_fmac_f32 v78, v43, v86
    v_fmac_f32 v79, v43, v87
    v_fmac_f32 v80, v43, v88
    v_fmac_f32 v81, v43, v89
    v_fmac_f32 v82, v43, v90
    v_fmac_f32 v83, v43, v91
    s_waitcnt vmcnt(15)
    v_lshlrev_b32 v84, 16, v100
    v_and_b32 v85, s61, v100
    v_lshlrev_b32 v86, 16, v101
    v_and_b32 v87, s61, v101
    v_lshlrev_b32 v88, 16, v102
    v_and_b32 v89, s61, v102
    v_lshlrev_b32 v90, 16, v103
    v_and_b32 v91, s61, v103
    s_mov_b32 s40, 53248
    buffer_load_dwordx4 v[100:103], v1, s[28:31], s40 offen offset:0 nt
    v_fmac_f32 v76, v44, v84
    v_fmac_f32 v77, v44, v85
    v_fmac_f32 v78, v44, v86
    v_fmac_f32 v79, v44, v87
    v_fmac_f32 v80, v44, v88
    v_fmac_f32 v81, v44, v89
    v_fmac_f32 v82, v44, v90
    v_fmac_f32 v83, v44, v91
    s_waitcnt vmcnt(15)
    v_lshlrev_b32 v84, 16, v104
    v_and_b32 v85, s61, v104
    v_lshlrev_b32 v86, 16, v105
    v_and_b32 v87, s61, v105
    v_lshlrev_b32 v88, 16, v106
    v_and_b32 v89, s61, v106
    v_lshlrev_b32 v90, 16, v107
    v_and_b32 v91, s61, v107
    s_mov_b32 s41, 53248
    buffer_load_dwordx4 v[104:107], v1, s[28:31], s41 offen offset:1024 nt
    v_fmac_f32 v76, v45, v84
    v_fmac_f32 v77, v45, v85
    v_fmac_f32 v78, v45, v86
    v_fmac_f32 v79, v45, v87
    v_fmac_f32 v80, v45, v88
    v_fmac_f32 v81, v45, v89
    v_fmac_f32 v82, v45, v90
    v_fmac_f32 v83, v45, v91
    s_waitcnt vmcnt(15)
    v_lshlrev_b32 v84, 16, v108
    v_and_b32 v85, s61, v108
    v_lshlrev_b32 v86, 16, v109
    v_and_b32 v87, s61, v109
    v_lshlrev_b32 v88, 16, v110
    v_and_b32 v89, s61, v110
    v_lshlrev_b32 v90, 16, v111
    v_and_b32 v91, s61, v111
    s_mov_b32 s42, 53248
    buffer_load_dwordx4 v[108:111], v1, s[28:31], s42 offen offset:2048 nt
    v_fmac_f32 v76, v46, v84
    v_fmac_f32 v77, v46, v85
    v_fmac_f32 v78, v46, v86
    v_fmac_f32 v79, v46, v87
    v_fmac_f32 v80, v46, v88
    v_fmac_f32 v81, v46, v89
    v_fmac_f32 v82, v46, v90
    v_fmac_f32 v83, v46, v91
    s_waitcnt vmcnt(15)
    v_lshlrev_b32 v84, 16, v112
    v_and_b32 v85, s61, v112
    v_lshlrev_b32 v86, 16, v113
    v_and_b32 v87, s61, v113
    v_lshlrev_b32 v88, 16, v114
    v_and_b32 v89, s61, v114
    v_lshlrev_b32 v90, 16, v115
    v_and_b32 v91, s61, v115
    s_mov_b32 s43, 53248
    buffer_load_dwordx4 v[112:115], v1, s[28:31], s43 offen offset:3072 nt
    v_fmac_f32 v76, v47, v84
    v_fmac_f32 v77, v47, v85
    v_fmac_f32 v78, v47, v86
    v_fmac_f32 v79, v47, v87
    v_fmac_f32 v80, v47, v88
    v_fmac_f32 v81, v47, v89
    v_fmac_f32 v82, v47, v90
    v_fmac_f32 v83, v47, v91
    s_waitcnt vmcnt(15)
    v_lshlrev_b32 v84, 16, v116
    v_and_b32 v85, s61, v116
    v_lshlrev_b32 v86, 16, v117
    v_and_b32 v87, s61, v117
    v_lshlrev_b32 v88, 16, v118
    v_and_b32 v89, s61, v118
    v_lshlrev_b32 v90, 16, v119
    v_and_b32 v91, s61, v119
    s_mov_b32 s44, 57344
    buffer_load_dwordx4 v[116:119], v1, s[28:31], s44 offen offset:0 nt
    v_fmac_f32 v76, v48, v84
    v_fmac_f32 v77, v48, v85
    v_fmac_f32 v78, v48, v86
    v_fmac_f32 v79, v48, v87
    v_fmac_f32 v80, v48, v88
    v_fmac_f32 v81, v48, v89
    v_fmac_f32 v82, v48, v90
    v_fmac_f32 v83, v48, v91
    s_waitcnt vmcnt(15)
    v_lshlrev_b32 v84, 16, v120
    v_and_b32 v85, s61, v120
    v_lshlrev_b32 v86, 16, v121
    v_and_b32 v87, s61, v121
    v_lshlrev_b32 v88, 16, v122
    v_and_b32 v89, s61, v122
    v_lshlrev_b32 v90, 16, v123
    v_and_b32 v91, s61, v123
    s_mov_b32 s45, 57344
    buffer_load_dwordx4 v[120:123], v1, s[28:31], s45 offen offset:1024 nt
    v_fmac_f32 v76, v49, v84
    v_fmac_f32 v77, v49, v85
    v_fmac_f32 v78, v49, v86
    v_fmac_f32 v79, v49, v87
    v_fmac_f32 v80, v49, v88
    v_fmac_f32 v81, v49, v89
    v_fmac_f32 v82, v49, v90
    v_fmac_f32 v83, v49, v91
    s_waitcnt vmcnt(15)
    v_lshlrev_b32 v84, 16, v124
    v_and_b32 v85, s61, v124
    v_lshlrev_b32 v86, 16, v125
    v_and_b32 v87, s61, v125
    v_lshlrev_b32 v88, 16, v126
    v_and_b32 v89, s61, v126
    v_lshlrev_b32 v90, 16, v127
    v_and_b32 v91, s61, v127
    s_mov_b32 s46, 57344
    buffer_load_dwordx4 v[124:127], v1, s[28:31], s46 offen offset:2048 nt
    v_fmac_f32 v76, v50, v84
    v_fmac_f32 v77, v50, v85
    v_fmac_f32 v78, v50, v86
    v_fmac_f32 v79, v50, v87
    v_fmac_f32 v80, v50, v88
    v_fmac_f32 v81, v50, v89
    v_fmac_f32 v82, v50, v90
    v_fmac_f32 v83, v50, v91
    s_waitcnt vmcnt(15)
    v_lshlrev_b32 v84, 16, v128
    v_and_b32 v85, s61, v128
    v_lshlrev_b32 v86, 16, v129
    v_and_b32 v87, s61, v129
    v_lshlrev_b32 v88, 16, v130
    v_and_b32 v89, s61, v130
    v_lshlrev_b32 v90, 16, v131
    v_and_b32 v91, s61, v131
    s_mov_b32 s47, 57344
    buffer_load_dwordx4 v[128:131], v1, s[28:31], s47 offen offset:3072 nt
    v_fmac_f32 v76, v51, v84
    v_fmac_f32 v77, v51, v85
    v_fmac_f32 v78, v51, v86
    v_fmac_f32 v79, v51, v87
    v_fmac_f32 v80, v51, v88
    v_fmac_f32 v81, v51, v89
    v_fmac_f32 v82, v51, v90
    v_fmac_f32 v83, v51, v91
    s_waitcnt vmcnt(15)
    v_lshlrev_b32 v84, 16, v132
    v_and_b32 v85, s61, v132
    v_lshlrev_b32 v86, 16, v133
    v_and_b32 v87, s61, v133
    v_lshlrev_b32 v88, 16, v134
    v_and_b32 v89, s61, v134
    v_lshlrev_b32 v90, 16, v135
    v_and_b32 v91, s61, v135
    v_fmac_f32 v76, v52, v84
    v_fmac_f32 v77, v52, v85
    v_fmac_f32 v78, v52, v86
    v_fmac_f32 v79, v52, v87
    v_fmac_f32 v80, v52, v88
    v_fmac_f32 v81, v52, v89
    v_fmac_f32 v82, v52, v90
    v_fmac_f32 v83, v52, v91
    s_waitcnt vmcnt(14)
    v_lshlrev_b32 v84, 16, v136
    v_and_b32 v85, s61, v136
    v_lshlrev_b32 v86, 16, v137
    v_and_b32 v87, s61, v137
    v_lshlrev_b32 v88, 16, v138
    v_and_b32 v89, s61, v138
    v_lshlrev_b32 v90, 16, v139
    v_and_b32 v91, s61, v139
    v_fmac_f32 v76, v53, v84
    v_fmac_f32 v77, v53, v85
    v_fmac_f32 v78, v53, v86
    v_fmac_f32 v79, v53, v87
    v_fmac_f32 v80, v53, v88
    v_fmac_f32 v81, v53, v89
    v_fmac_f32 v82, v53, v90
    v_fmac_f32 v83, v53, v91
    s_waitcnt vmcnt(13)
    v_lshlrev_b32 v84, 16, v140
    v_and_b32 v85, s61, v140
    v_lshlrev_b32 v86, 16, v141
    v_and_b32 v87, s61, v141
    v_lshlrev_b32 v88, 16, v142
    v_and_b32 v89, s61, v142
    v_lshlrev_b32 v90, 16, v143
    v_and_b32 v91, s61, v143
    v_fmac_f32 v76, v54, v84
    v_fmac_f32 v77, v54, v85
    v_fmac_f32 v78, v54, v86
    v_fmac_f32 v79, v54, v87
    v_fmac_f32 v80, v54, v88
    v_fmac_f32 v81, v54, v89
    v_fmac_f32 v82, v54, v90
    v_fmac_f32 v83, v54, v91
    s_waitcnt vmcnt(12)
    v_lshlrev_b32 v84, 16, v144
    v_and_b32 v85, s61, v144
    v_lshlrev_b32 v86, 16, v145
    v_and_b32 v87, s61, v145
    v_lshlrev_b32 v88, 16, v146
    v_and_b32 v89, s61, v146
    v_lshlrev_b32 v90, 16, v147
    v_and_b32 v91, s61, v147
    v_fmac_f32 v76, v55, v84
    v_fmac_f32 v77, v55, v85
    v_fmac_f32 v78, v55, v86
    v_fmac_f32 v79, v55, v87
    v_fmac_f32 v80, v55, v88
    v_fmac_f32 v81, v55, v89
    v_fmac_f32 v82, v55, v90
    v_fmac_f32 v83, v55, v91
    s_waitcnt vmcnt(11)
    v_lshlrev_b32 v84, 16, v148
    v_and_b32 v85, s61, v148
    v_lshlrev_b32 v86, 16, v149
    v_and_b32 v87, s61, v149
    v_lshlrev_b32 v88, 16, v150
    v_and_b32 v89, s61, v150
    v_lshlrev_b32 v90, 16, v151
    v_and_b32 v91, s61, v151
    v_fmac_f32 v76, v56, v84
    v_fmac_f32 v77, v56, v85
    v_fmac_f32 v78, v56, v86
    v_fmac_f32 v79, v56, v87
    v_fmac_f32 v80, v56, v88
    v_fmac_f32 v81, v56, v89
    v_fmac_f32 v82, v56, v90
    v_fmac_f32 v83, v56, v91
    s_waitcnt vmcnt(10)
    v_lshlrev_b32 v84, 16, v152
    v_and_b32 v85, s61, v152
    v_lshlrev_b32 v86, 16, v153
    v_and_b32 v87, s61, v153
    v_lshlrev_b32 v88, 16, v154
    v_and_b32 v89, s61, v154
    v_lshlrev_b32 v90, 16, v155
    v_and_b32 v91, s61, v155
    v_fmac_f32 v76, v57, v84
    v_fmac_f32 v77, v57, v85
    v_fmac_f32 v78, v57, v86
    v_fmac_f32 v79, v57, v87
    v_fmac_f32 v80, v57, v88
    v_fmac_f32 v81, v57, v89
    v_fmac_f32 v82, v57, v90
    v_fmac_f32 v83, v57, v91
    s_waitcnt vmcnt(9)
    v_lshlrev_b32 v84, 16, v156
    v_and_b32 v85, s61, v156
    v_lshlrev_b32 v86, 16, v157
    v_and_b32 v87, s61, v157
    v_lshlrev_b32 v88, 16, v158
    v_and_b32 v89, s61, v158
    v_lshlrev_b32 v90, 16, v159
    v_and_b32 v91, s61, v159
    v_fmac_f32 v76, v58, v84
    v_fmac_f32 v77, v58, v85
    v_fmac_f32 v78, v58, v86
    v_fmac_f32 v79, v58, v87
    v_fmac_f32 v80, v58, v88
    v_fmac_f32 v81, v58, v89
    v_fmac_f32 v82, v58, v90
    v_fmac_f32 v83, v58, v91
    s_waitcnt vmcnt(8)
    v_lshlrev_b32 v84, 16, v160
    v_and_b32 v85, s61, v160
    v_lshlrev_b32 v86, 16, v161
    v_and_b32 v87, s61, v161
    v_lshlrev_b32 v88, 16, v162
    v_and_b32 v89, s61, v162
    v_lshlrev_b32 v90, 16, v163
    v_and_b32 v91, s61, v163
    v_fmac_f32 v76, v59, v84
    v_fmac_f32 v77, v59, v85
    v_fmac_f32 v78, v59, v86
    v_fmac_f32 v79, v59, v87
    v_fmac_f32 v80, v59, v88
    v_fmac_f32 v81, v59, v89
    v_fmac_f32 v82, v59, v90
    v_fmac_f32 v83, v59, v91
    s_waitcnt vmcnt(7)
    v_lshlrev_b32 v84, 16, v100
    v_and_b32 v85, s61, v100
    v_lshlrev_b32 v86, 16, v101
    v_and_b32 v87, s61, v101
    v_lshlrev_b32 v88, 16, v102
    v_and_b32 v89, s61, v102
    v_lshlrev_b32 v90, 16, v103
    v_and_b32 v91, s61, v103
    v_fmac_f32 v76, v60, v84
    v_fmac_f32 v77, v60, v85
    v_fmac_f32 v78, v60, v86
    v_fmac_f32 v79, v60, v87
    v_fmac_f32 v80, v60, v88
    v_fmac_f32 v81, v60, v89
    v_fmac_f32 v82, v60, v90
    v_fmac_f32 v83, v60, v91
    s_waitcnt vmcnt(6)
    v_lshlrev_b32 v84, 16, v104
    v_and_b32 v85, s61, v104
    v_lshlrev_b32 v86, 16, v105
    v_and_b32 v87, s61, v105
    v_lshlrev_b32 v88, 16, v106
    v_and_b32 v89, s61, v106
    v_lshlrev_b32 v90, 16, v107
    v_and_b32 v91, s61, v107
    v_fmac_f32 v76, v61, v84
    v_fmac_f32 v77, v61, v85
    v_fmac_f32 v78, v61, v86
    v_fmac_f32 v79, v61, v87
    v_fmac_f32 v80, v61, v88
    v_fmac_f32 v81, v61, v89
    v_fmac_f32 v82, v61, v90
    v_fmac_f32 v83, v61, v91
    s_waitcnt vmcnt(5)
    v_lshlrev_b32 v84, 16, v108
    v_and_b32 v85, s61, v108
    v_lshlrev_b32 v86, 16, v109
    v_and_b32 v87, s61, v109
    v_lshlrev_b32 v88, 16, v110
    v_and_b32 v89, s61, v110
    v_lshlrev_b32 v90, 16, v111
    v_and_b32 v91, s61, v111
    v_fmac_f32 v76, v62, v84
    v_fmac_f32 v77, v62, v85
    v_fmac_f32 v78, v62, v86
    v_fmac_f32 v79, v62, v87
    v_fmac_f32 v80, v62, v88
    v_fmac_f32 v81, v62, v89
    v_fmac_f32 v82, v62, v90
    v_fmac_f32 v83, v62, v91
    s_waitcnt vmcnt(4)
    v_lshlrev_b32 v84, 16, v112
    v_and_b32 v85, s61, v112
    v_lshlrev_b32 v86, 16, v113
    v_and_b32 v87, s61, v113
    v_lshlrev_b32 v88, 16, v114
    v_and_b32 v89, s61, v114
    v_lshlrev_b32 v90, 16, v115
    v_and_b32 v91, s61, v115
    v_fmac_f32 v76, v63, v84
    v_fmac_f32 v77, v63, v85
    v_fmac_f32 v78, v63, v86
    v_fmac_f32 v79, v63, v87
    v_fmac_f32 v80, v63, v88
    v_fmac_f32 v81, v63, v89
    v_fmac_f32 v82, v63, v90
    v_fmac_f32 v83, v63, v91
    s_waitcnt vmcnt(3)
    v_lshlrev_b32 v84, 16, v116
    v_and_b32 v85, s61, v116
    v_lshlrev_b32 v86, 16, v117
    v_and_b32 v87, s61, v117
    v_lshlrev_b32 v88, 16, v118
    v_and_b32 v89, s61, v118
    v_lshlrev_b32 v90, 16, v119
    v_and_b32 v91, s61, v119
    v_fmac_f32 v76, v64, v84
    v_fmac_f32 v77, v64, v85
    v_fmac_f32 v78, v64, v86
    v_fmac_f32 v79, v64, v87
    v_fmac_f32 v80, v64, v88
    v_fmac_f32 v81, v64, v89
    v_fmac_f32 v82, v64, v90
    v_fmac_f32 v83, v64, v91
    s_waitcnt vmcnt(2)
    v_lshlrev_b32 v84, 16, v120
    v_and_b32 v85, s61, v120
    v_lshlrev_b32 v86, 16, v121
    v_and_b32 v87, s61, v121
    v_lshlrev_b32 v88, 16, v122
    v_and_b32 v89, s61, v122
    v_lshlrev_b32 v90, 16, v123
    v_and_b32 v91, s61, v123
    v_fmac_f32 v76, v65, v84
    v_fmac_f32 v77, v65, v85
    v_fmac_f32 v78, v65, v86
    v_fmac_f32 v79, v65, v87
    v_fmac_f32 v80, v65, v88
    v_fmac_f32 v81, v65, v89
    v_fmac_f32 v82, v65, v90
    v_fmac_f32 v83, v65, v91
    s_waitcnt vmcnt(1)
    v_lshlrev_b32 v84, 16, v124
    v_and_b32 v85, s61, v124
    v_lshlrev_b32 v86, 16, v125
    v_and_b32 v87, s61, v125
    v_lshlrev_b32 v88, 16, v126
    v_and_b32 v89, s61, v126
    v_lshlrev_b32 v90, 16, v127
    v_and_b32 v91, s61, v127
    v_fmac_f32 v76, v66, v84
    v_fmac_f32 v77, v66, v85
    v_fmac_f32 v78, v66, v86
    v_fmac_f32 v79, v66, v87
    v_fmac_f32 v80, v66, v88
    v_fmac_f32 v81, v66, v89
    v_fmac_f32 v82, v66, v90
    v_fmac_f32 v83, v66, v91
    s_waitcnt vmcnt(0)
    v_lshlrev_b32 v84, 16, v128
    v_and_b32 v85, s61, v128
    v_lshlrev_b32 v86, 16, v129
    v_and_b32 v87, s61, v129
    v_lshlrev_b32 v88, 16, v130
    v_and_b32 v89, s61, v130
    v_lshlrev_b32 v90, 16, v131
    v_and_b32 v91, s61, v131
    v_fmac_f32 v76, v67, v84
    v_fmac_f32 v77, v67, v85
    v_fmac_f32 v78, v67, v86
    v_fmac_f32 v79, v67, v87
    v_fmac_f32 v80, v67, v88
    v_fmac_f32 v81, v67, v89
    v_fmac_f32 v82, v67, v90
    v_fmac_f32 v83, v67, v91
    s_branch L_join
L_big:
    s_waitcnt vmcnt(15)
    v_dot2_f32_bf16 v52, v148, v4, 0
    v_dot2_f32_bf16 v52, v149, v5, v52
    v_dot2_f32_bf16 v52, v150, v6, v52
    v_dot2_f32_bf16 v52, v151, v7, v52
    buffer_load_dwordx4 v[148:151], v2, s[24:27], 0 offen offset:0 nt
    v_add_f32_dpp v48, v48, v48 row_ror:8 row_mask:0xf bank_mask:0xf
    v_add_f32_dpp v49, v49, v49 row_ror:8 row_mask:0xf bank_mask:0xf
    v_add_f32_dpp v50, v50, v50 row_ror:8 row_mask:0xf bank_mask:0xf
    v_add_f32_dpp v51, v51, v51 row_ror:8 row_mask:0xf bank_mask:0xf
    v_add_f32_dpp v48, v48, v48 row_ror:4 row_mask:0xf bank_mask:0xf
    v_add_f32_dpp v49, v49, v49 row_ror:4 row_mask:0xf bank_mask:0xf
    v_add_f32_dpp v50, v50, v50 row_ror:4 row_mask:0xf bank_mask:0xf
    v_add_f32_dpp v51, v51, v51 row_ror:4 row_mask:0xf bank_mask:0xf
    v_add_f32_dpp v48, v48, v48 row_ror:2 row_mask:0xf bank_mask:0xf
    v_add_f32_dpp v49, v49, v49 row_ror:2 row_mask:0xf bank_mask:0xf
    v_add_f32_dpp v50, v50, v50 row_ror:2 row_mask:0xf bank_mask:0xf
    v_add_f32_dpp v51, v51, v51 row_ror:2 row_mask:0xf bank_mask:0xf
    v_add_f32_dpp v48, v48, v48 row_ror:1 row_mask:0xf bank_mask:0xf
    v_add_f32_dpp v49, v49, v49 row_ror:1 row_mask:0xf bank_mask:0xf
    v_add_f32_dpp v50, v50, v50 row_ror:1 row_mask:0xf bank_mask:0xf
    v_add_f32_dpp v51, v51, v51 row_ror:1 row_mask:0xf bank_mask:0xf
    s_waitcnt vmcnt(15)
    v_dot2_f32_bf16 v53, v152, v4, 0
    v_dot2_f32_bf16 v53, v153, v5, v53
    v_dot2_f32_bf16 v53, v154, v6, v53
    v_dot2_f32_bf16 v53, v155, v7, v53
    buffer_load_dwordx4 v[152:155], v2, s[24:27], 0 offen offset:1024 nt
    s_waitcnt vmcnt(15)
    v_dot2_f32_bf16 v54, v156, v4, 0
    v_dot2_f32_bf16 v54, v157, v5, v54
    v_dot2_f32_bf16 v54, v158, v6, v54
    v_dot2_f32_bf16 v54, v159, v7, v54
    buffer_load_dwordx4 v[156:159], v2, s[24:27], 0 offen offset:2048 nt
    s_waitcnt vmcnt(15)
    v_dot2_f32_bf16 v55, v160, v4, 0
    v_dot2_f32_bf16 v55, v161, v5, v55
    v_dot2_f32_bf16 v55, v162, v6, v55
    v_dot2_f32_bf16 v55, v163, v7, v55
    buffer_load_dwordx4 v[160:163], v2, s[24:27], 0 offen offset:3072 nt
    s_waitcnt vmcnt(15)
    v_dot2_f32_bf16 v56, v100, v4, 0
    v_dot2_f32_bf16 v56, v101, v5, v56
    v_dot2_f32_bf16 v56, v102, v6, v56
    v_dot2_f32_bf16 v56, v103, v7, v56
    s_mov_b32 s40, 4096
    buffer_load_dwordx4 v[100:103], v2, s[24:27], s40 offen offset:0 nt
    v_add_f32_dpp v52, v52, v52 row_ror:8 row_mask:0xf bank_mask:0xf
    v_add_f32_dpp v53, v53, v53 row_ror:8 row_mask:0xf bank_mask:0xf
    v_add_f32_dpp v54, v54, v54 row_ror:8 row_mask:0xf bank_mask:0xf
    v_add_f32_dpp v55, v55, v55 row_ror:8 row_mask:0xf bank_mask:0xf
    v_add_f32_dpp v52, v52, v52 row_ror:4 row_mask:0xf bank_mask:0xf
    v_add_f32_dpp v53, v53, v53 row_ror:4 row_mask:0xf bank_mask:0xf
    v_add_f32_dpp v54, v54, v54 row_ror:4 row_mask:0xf bank_mask:0xf
    v_add_f32_dpp v55, v55, v55 row_ror:4 row_mask:0xf bank_mask:0xf
    v_add_f32_dpp v52, v52, v52 row_ror:2 row_mask:0xf bank_mask:0xf
    v_add_f32_dpp v53, v53, v53 row_ror:2 row_mask:0xf bank_mask:0xf
    v_add_f32_dpp v54, v54, v54 row_ror:2 row_mask:0xf bank_mask:0xf
    v_add_f32_dpp v55, v55, v55 row_ror:2 row_mask:0xf bank_mask:0xf
    v_add_f32_dpp v52, v52, v52 row_ror:1 row_mask:0xf bank_mask:0xf
    v_add_f32_dpp v53, v53, v53 row_ror:1 row_mask:0xf bank_mask:0xf
    v_add_f32_dpp v54, v54, v54 row_ror:1 row_mask:0xf bank_mask:0xf
    v_add_f32_dpp v55, v55, v55 row_ror:1 row_mask:0xf bank_mask:0xf
    s_waitcnt vmcnt(15)
    v_dot2_f32_bf16 v57, v104, v4, 0
    v_dot2_f32_bf16 v57, v105, v5, v57
    v_dot2_f32_bf16 v57, v106, v6, v57
    v_dot2_f32_bf16 v57, v107, v7, v57
    s_mov_b32 s41, 4096
    buffer_load_dwordx4 v[104:107], v2, s[24:27], s41 offen offset:1024 nt
    s_waitcnt vmcnt(15)
    v_dot2_f32_bf16 v58, v108, v4, 0
    v_dot2_f32_bf16 v58, v109, v5, v58
    v_dot2_f32_bf16 v58, v110, v6, v58
    v_dot2_f32_bf16 v58, v111, v7, v58
    s_mov_b32 s42, 4096
    buffer_load_dwordx4 v[108:111], v2, s[24:27], s42 offen offset:2048 nt
    s_waitcnt vmcnt(15)
    v_dot2_f32_bf16 v59, v112, v4, 0
    v_dot2_f32_bf16 v59, v113, v5, v59
    v_dot2_f32_bf16 v59, v114, v6, v59
    v_dot2_f32_bf16 v59, v115, v7, v59
    s_mov_b32 s43, 4096
    buffer_load_dwordx4 v[112:115], v2, s[24:27], s43 offen offset:3072 nt
    s_waitcnt vmcnt(15)
    v_dot2_f32_bf16 v60, v116, v4, 0
    v_dot2_f32_bf16 v60, v117, v5, v60
    v_dot2_f32_bf16 v60, v118, v6, v60
    v_dot2_f32_bf16 v60, v119, v7, v60
    buffer_load_dwordx4 v[116:119], v1, s[28:31], 0 offen offset:0 nt
    v_add_f32_dpp v56, v56, v56 row_ror:8 row_mask:0xf bank_mask:0xf
    v_add_f32_dpp v57, v57, v57 row_ror:8 row_mask:0xf bank_mask:0xf
    v_add_f32_dpp v58, v58, v58 row_ror:8 row_mask:0xf bank_mask:0xf
    v_add_f32_dpp v59, v59, v59 row_ror:8 row_mask:0xf bank_mask:0xf
    v_add_f32_dpp v56, v56, v56 row_ror:4 row_mask:0xf bank_mask:0xf
    v_add_f32_dpp v57, v57, v57 row_ror:4 row_mask:0xf bank_mask:0xf
    v_add_f32_dpp v58, v58, v58 row_ror:4 row_mask:0xf bank_mask:0xf
    v_add_f32_dpp v59, v59, v59 row_ror:4 row_mask:0xf bank_mask:0xf
    v_add_f32_dpp v56, v56, v56 row_ror:2 row_mask:0xf bank_mask:0xf
    v_add_f32_dpp v57, v57, v57 row_ror:2 row_mask:0xf bank_mask:0xf
    v_add_f32_dpp v58, v58, v58 row_ror:2 row_mask:0xf bank_mask:0xf
    v_add_f32_dpp v59, v59, v59 row_ror:2 row_mask:0xf bank_mask:0xf
    v_add_f32_dpp v56, v56, v56 row_ror:1 row_mask:0xf bank_mask:0xf
    v_add_f32_dpp v57, v57, v57 row_ror:1 row_mask:0xf bank_mask:0xf
    v_add_f32_dpp v58, v58, v58 row_ror:1 row_mask:0xf bank_mask:0xf
    v_add_f32_dpp v59, v59, v59 row_ror:1 row_mask:0xf bank_mask:0xf
    s_waitcnt vmcnt(15)
    v_dot2_f32_bf16 v61, v120, v4, 0
    v_dot2_f32_bf16 v61, v121, v5, v61
    v_dot2_f32_bf16 v61, v122, v6, v61
    v_dot2_f32_bf16 v61, v123, v7, v61
    buffer_load_dwordx4 v[120:123], v1, s[28:31], 0 offen offset:1024 nt
    s_waitcnt vmcnt(15)
    v_dot2_f32_bf16 v62, v124, v4, 0
    v_dot2_f32_bf16 v62, v125, v5, v62
    v_dot2_f32_bf16 v62, v126, v6, v62
    v_dot2_f32_bf16 v62, v127, v7, v62
    buffer_load_dwordx4 v[124:127], v1, s[28:31], 0 offen offset:2048 nt
    s_waitcnt vmcnt(15)
    v_dot2_f32_bf16 v63, v128, v4, 0
    v_dot2_f32_bf16 v63, v129, v5, v63
    v_dot2_f32_bf16 v63, v130, v6, v63
    v_dot2_f32_bf16 v63, v131, v7, v63
    buffer_load_dwordx4 v[128:131], v1, s[28:31], 0 offen offset:3072 nt
    s_waitcnt vmcnt(15)
    v_dot2_f32_bf16 v64, v132, v4, 0
    v_dot2_f32_bf16 v64, v133, v5, v64
    v_dot2_f32_bf16 v64, v134, v6, v64
    v_dot2_f32_bf16 v64, v135, v7, v64
    s_mov_b32 s40, 4096
    buffer_load_dwordx4 v[132:135], v1, s[28:31], s40 offen offset:0 nt
    v_add_f32_dpp v60, v60, v60 row_ror:8 row_mask:0xf bank_mask:0xf
    v_add_f32_dpp v61, v61, v61 row_ror:8 row_mask:0xf bank_mask:0xf
    v_add_f32_dpp v62, v62, v62 row_ror:8 row_mask:0xf bank_mask:0xf
    v_add_f32_dpp v63, v63, v63 row_ror:8 row_mask:0xf bank_mask:0xf
    v_add_f32_dpp v60, v60, v60 row_ror:4 row_mask:0xf bank_mask:0xf
    v_add_f32_dpp v61, v61, v61 row_ror:4 row_mask:0xf bank_mask:0xf
    v_add_f32_dpp v62, v62, v62 row_ror:4 row_mask:0xf bank_mask:0xf
    v_add_f32_dpp v63, v63, v63 row_ror:4 row_mask:0xf bank_mask:0xf
    v_add_f32_dpp v60, v60, v60 row_ror:2 row_mask:0xf bank_mask:0xf
    v_add_f32_dpp v61, v61, v61 row_ror:2 row_mask:0xf bank_mask:0xf
    v_add_f32_dpp v62, v62, v62 row_ror:2 row_mask:0xf bank_mask:0xf
    v_add_f32_dpp v63, v63, v63 row_ror:2 row_mask:0xf bank_mask:0xf
    v_add_f32_dpp v60, v60, v60 row_ror:1 row_mask:0xf bank_mask:0xf
    v_add_f32_dpp v61, v61, v61 row_ror:1 row_mask:0xf bank_mask:0xf
    v_add_f32_dpp v62, v62, v62 row_ror:1 row_mask:0xf bank_mask:0xf
    v_add_f32_dpp v63, v63, v63 row_ror:1 row_mask:0xf bank_mask:0xf
    s_waitcnt vmcnt(15)
    v_dot2_f32_bf16 v65, v136, v4, 0
    v_dot2_f32_bf16 v65, v137, v5, v65
    v_dot2_f32_bf16 v65, v138, v6, v65
    v_dot2_f32_bf16 v65, v139, v7, v65
    s_mov_b32 s41, 4096
    buffer_load_dwordx4 v[136:139], v1, s[28:31], s41 offen offset:1024 nt
    s_waitcnt vmcnt(15)
    v_dot2_f32_bf16 v66, v140, v4, 0
    v_dot2_f32_bf16 v66, v141, v5, v66
    v_dot2_f32_bf16 v66, v142, v6, v66
    v_dot2_f32_bf16 v66, v143, v7, v66
    s_mov_b32 s42, 4096
    buffer_load_dwordx4 v[140:143], v1, s[28:31], s42 offen offset:2048 nt
    s_waitcnt vmcnt(15)
    v_dot2_f32_bf16 v67, v144, v4, 0
    v_dot2_f32_bf16 v67, v145, v5, v67
    v_dot2_f32_bf16 v67, v146, v6, v67
    v_dot2_f32_bf16 v67, v147, v7, v67
    s_mov_b32 s43, 4096
    buffer_load_dwordx4 v[144:147], v1, s[28:31], s43 offen offset:3072 nt
    s_waitcnt vmcnt(15)
    v_dot2_f32_bf16 v68, v148, v4, 0
    v_dot2_f32_bf16 v68, v149, v5, v68
    v_dot2_f32_bf16 v68, v150, v6, v68
    v_dot2_f32_bf16 v68, v151, v7, v68
    s_mov_b32 s44, 8192
    buffer_load_dwordx4 v[148:151], v1, s[28:31], s44 offen offset:0 nt
    v_add_f32_dpp v64, v64, v64 row_ror:8 row_mask:0xf bank_mask:0xf
    v_add_f32_dpp v65, v65, v65 row_ror:8 row_mask:0xf bank_mask:0xf
    v_add_f32_dpp v66, v66, v66 row_ror:8 row_mask:0xf bank_mask:0xf
    v_add_f32_dpp v67, v67, v67 row_ror:8 row_mask:0xf bank_mask:0xf
    v_add_f32_dpp v64, v64, v64 row_ror:4 row_mask:0xf bank_mask:0xf
    v_add_f32_dpp v65, v65, v65 row_ror:4 row_mask:0xf bank_mask:0xf
    v_add_f32_dpp v66, v66, v66 row_ror:4 row_mask:0xf bank_mask:0xf
    v_add_f32_dpp v67, v67, v67 row_ror:4 row_mask:0xf bank_mask:0xf
    v_add_f32_dpp v64, v64, v64 row_ror:2 row_mask:0xf bank_mask:0xf
    v_add_f32_dpp v65, v65, v65 row_ror:2 row_mask:0xf bank_mask:0xf
    v_add_f32_dpp v66, v66, v66 row_ror:2 row_mask:0xf bank_mask:0xf
    v_add_f32_dpp v67, v67, v67 row_ror:2 row_mask:0xf bank_mask:0xf
    v_add_f32_dpp v64, v64, v64 row_ror:1 row_mask:0xf bank_mask:0xf
    v_add_f32_dpp v65, v65, v65 row_ror:1 row_mask:0xf bank_mask:0xf
    v_add_f32_dpp v66, v66, v66 row_ror:1 row_mask:0xf bank_mask:0xf
    v_add_f32_dpp v67, v67, v67 row_ror:1 row_mask:0xf bank_mask:0xf
    s_waitcnt vmcnt(15)
    v_dot2_f32_bf16 v69, v152, v4, 0
    v_dot2_f32_bf16 v69, v153, v5, v69
    v_dot2_f32_bf16 v69, v154, v6, v69
    v_dot2_f32_bf16 v69, v155, v7, v69
    s_mov_b32 s45, 8192
    buffer_load_dwordx4 v[152:155], v1, s[28:31], s45 offen offset:1024 nt
    s_waitcnt vmcnt(15)
    v_dot2_f32_bf16 v70, v156, v4, 0
    v_dot2_f32_bf16 v70, v157, v5, v70
    v_dot2_f32_bf16 v70, v158, v6, v70
    v_dot2_f32_bf16 v70, v159, v7, v70
    s_mov_b32 s46, 8192
    buffer_load_dwordx4 v[156:159], v1, s[28:31], s46 offen offset:2048 nt
    s_waitcnt vmcnt(15)
    v_dot2_f32_bf16 v71, v160, v4, 0
    v_dot2_f32_bf16 v71, v161, v5, v71
    v_dot2_f32_bf16 v71, v162, v6, v71
    v_dot2_f32_bf16 v71, v163, v7, v71
    s_mov_b32 s47, 8192
    buffer_load_dwordx4 v[160:163], v1, s[28:31], s47 offen offset:3072 nt
    s_waitcnt vmcnt(15)
    v_dot2_f32_bf16 v72, v100, v4, 0
    v_dot2_f32_bf16 v72, v101, v5, v72
    v_dot2_f32_bf16 v72, v102, v6, v72
    v_dot2_f32_bf16 v72, v103, v7, v72
    s_mov_b32 s40, 12288
    buffer_load_dwordx4 v[100:103], v1, s[28:31], s40 offen offset:0 nt
    v_add_f32_dpp v68, v68, v68 row_ror:8 row_mask:0xf bank_mask:0xf
    v_add_f32_dpp v69, v69, v69 row_ror:8 row_mask:0xf bank_mask:0xf
    v_add_f32_dpp v70, v70, v70 row_ror:8 row_mask:0xf bank_mask:0xf
    v_add_f32_dpp v71, v71, v71 row_ror:8 row_mask:0xf bank_mask:0xf
    v_add_f32_dpp v68, v68, v68 row_ror:4 row_mask:0xf bank_mask:0xf
    v_add_f32_dpp v69, v69, v69 row_ror:4 row_mask:0xf bank_mask:0xf
    v_add_f32_dpp v70, v70, v70 row_ror:4 row_mask:0xf bank_mask:0xf
    v_add_f32_dpp v71, v71, v71 row_ror:4 row_mask:0xf bank_mask:0xf
    v_add_f32_dpp v68, v68, v68 row_ror:2 row_mask:0xf bank_mask:0xf
    v_add_f32_dpp v69, v69, v69 row_ror:2 row_mask:0xf bank_mask:0xf
    v_add_f32_dpp v70, v70, v70 row_ror:2 row_mask:0xf bank_mask:0xf
    v_add_f32_dpp v71, v71, v71 row_ror:2 row_mask:0xf bank_mask:0xf
    v_add_f32_dpp v68, v68, v68 row_ror:1 row_mask:0xf bank_mask:0xf
    v_add_f32_dpp v69, v69, v69 row_ror:1 row_mask:0xf bank_mask:0xf
    v_add_f32_dpp v70, v70, v70 row_ror:1 row_mask:0xf bank_mask:0xf
    v_add_f32_dpp v71, v71, v71 row_ror:1 row_mask:0xf bank_mask:0xf
    s_waitcnt vmcnt(15)
    v_dot2_f32_bf16 v73, v104, v4, 0
    v_dot2_f32_bf16 v73, v105, v5, v73
    v_dot2_f32_bf16 v73, v106, v6, v73
    v_dot2_f32_bf16 v73, v107, v7, v73
    s_mov_b32 s41, 12288
    buffer_load_dwordx4 v[104:107], v1, s[28:31], s41 offen offset:1024 nt
    s_waitcnt vmcnt(15)
    v_dot2_f32_bf16 v74, v108, v4, 0
    v_dot2_f32_bf16 v74, v109, v5, v74
    v_dot2_f32_bf16 v74, v110, v6, v74
    v_dot2_f32_bf16 v74, v111, v7, v74
    s_mov_b32 s42, 12288
    buffer_load_dwordx4 v[108:111], v1, s[28:31], s42 offen offset:2048 nt
    s_waitcnt vmcnt(15)
    v_dot2_f32_bf16 v75, v112, v4, 0
    v_dot2_f32_bf16 v75, v113, v5, v75
    v_dot2_f32_bf16 v75, v114, v6, v75
    v_dot2_f32_bf16 v75, v115, v7, v75
    s_mov_b32 s43, 12288
    buffer_load_dwordx4 v[112:115], v1, s[28:31], s43 offen offset:3072 nt
    s_nop 3
    v_add_f32_dpp v72, v72, v72 row_ror:8 row_mask:0xf bank_mask:0xf
    v_add_f32_dpp v73, v73, v73 row_ror:8 row_mask:0xf bank_mask:0xf
    v_add_f32_dpp v74, v74, v74 row_ror:8 row_mask:0xf bank_mask:0xf
    v_add_f32_dpp v75, v75, v75 row_ror:8 row_mask:0xf bank_mask:0xf
    v_add_f32_dpp v72, v72, v72 row_ror:4 row_mask:0xf bank_mask:0xf
    v_add_f32_dpp v73, v73, v73 row_ror:4 row_mask:0xf bank_mask:0xf
    v_add_f32_dpp v74, v74, v74 row_ror:4 row_mask:0xf bank_mask:0xf
    v_add_f32_dpp v75, v75, v75 row_ror:4 row_mask:0xf bank_mask:0xf
    v_add_f32_dpp v72, v72, v72 row_ror:2 row_mask:0xf bank_mask:0xf
    v_add_f32_dpp v73, v73, v73 row_ror:2 row_mask:0xf bank_mask:0xf
    v_add_f32_dpp v74, v74, v74 row_ror:2 row_mask:0xf bank_mask:0xf
    v_add_f32_dpp v75, v75, v75 row_ror:2 row_mask:0xf bank_mask:0xf
    v_add_f32_dpp v72, v72, v72 row_ror:1 row_mask:0xf bank_mask:0xf
    v_add_f32_dpp v73, v73, v73 row_ror:1 row_mask:0xf bank_mask:0xf
    v_add_f32_dpp v74, v74, v74 row_ror:1 row_mask:0xf bank_mask:0xf
    v_add_f32_dpp v75, v75, v75 row_ror:1 row_mask:0xf bank_mask:0xf
    v_max3_f32 v92, v8, v9, v10
    v_max3_f32 v92, v92, v11, v12
    v_max3_f32 v92, v92, v13, v14
    v_max3_f32 v92, v92, v15, v16
    v_max3_f32 v92, v92, v17, v18
    v_max3_f32 v92, v92, v19, v20
    v_max3_f32 v92, v92, v21, v22
    v_max3_f32 v92, v92, v23, v24
    v_max3_f32 v92, v92, v25, v26
    v_max3_f32 v92, v92, v27, v28
    v_max3_f32 v92, v92, v29, v30
    v_max3_f32 v92, v92, v31, v32
    v_max3_f32 v92, v92, v33, v34
    v_max3_f32 v92, v92, v35, v36
    v_max3_f32 v92, v92, v37, v38
    v_max3_f32 v92, v92, v39, v40
    v_max3_f32 v92, v92, v41, v42
    v_max3_f32 v92, v92, v43, v44
    v_max3_f32 v92, v92, v45, v46
    v_max3_f32 v92, v92, v47, v48
    v_max3_f32 v92, v92, v49, v50
    v_max3_f32 v92, v92, v51, v52
    v_max3_f32 v92, v92, v53, v54
    v_max3_f32 v92, v92, v55, v56
    v_max3_f32 v92, v92, v57, v58
    v_max3_f32 v92, v92, v59, v60
    v_max3_f32 v92, v92, v61, v62
    v_max3_f32 v92, v92, v63, v64
    v_max3_f32 v92, v92, v65, v66
    v_max3_f32 v92, v92, v67, v68
    v_max3_f32 v92, v92, v69, v70
    v_max3_f32 v92, v92, v71, v72
    v_max3_f32 v92, v92, v73, v74
    v_max_f32 v92, v92, v75
    v_mov_b32 v93, v92
    s_nop 1
    v_permlane32_swap_b32 v92, v93
    s_nop 1
    v_max_f32 v92, v92, v93
    v_mov_b32 v93, v92
    s_nop 1
    v_permlane16_swap_b32 v92, v93
    s_nop 1
    v_max_f32 v92, v92, v93
    v_mul_f32 v93, s60, v92
    v_fma_f32 v8, v8, s60, -v93
    v_fma_f32 v9, v9, s60, -v93
    v_fma_f32 v10, v10, s60, -v93
    v_fma_f32 v11, v11, s60, -v93
    v_fma_f32 v12, v12, s60, -v93
    v_fma_f32 v13, v13, s60, -v93
    v_fma_f32 v14, v14, s60, -v93
    v_fma_f32 v15, v15, s60, -v93
    v_fma_f32 v16, v16, s60, -v93
    v_fma_f32 v17, v17, s60, -v93
    v_fma_f32 v18, v18, s60, -v93
    v_fma_f32 v19, v19, s60, -v93
    v_fma_f32 v20, v20, s60, -v93
    v_fma_f32 v21, v21, s60, -v93
    v_fma_f32 v22, v22, s60, -v93
    v_fma_f32 v23, v23, s60, -v93
    v_fma_f32 v24, v24, s60, -v93
    v_fma_f32 v25, v25, s60, -v93
    v_fma_f32 v26, v26, s60, -v93
    v_fma_f32 v27, v27, s60, -v93
    v_fma_f32 v28, v28, s60, -v93
    v_fma_f32 v29, v29, s60, -v93
    v_fma_f32 v30, v30, s60, -v93
    v_fma_f32 v31, v31, s60, -v93
    v_fma_f32 v32, v32, s60, -v93
    v_fma_f32 v33, v33, s60, -v93
    v_fma_f32 v34, v34, s60, -v93
    v_fma_f32 v35, v35, s60, -v93
    v_fma_f32 v36, v36, s60, -v93
    v_fma_f32 v37, v37, s60, -v93
    v_fma_f32 v38, v38, s60, -v93
    v_fma_f32 v39, v39, s60, -v93
    v_fma_f32 v40, v40, s60, -v93
    v_fma_f32 v41, v41, s60, -v93
    v_fma_f32 v42, v42, s60, -v93
    v_fma_f32 v43, v43, s60, -v93
    v_fma_f32 v44, v44, s60, -v93
    v_fma_f32 v45, v45, s60, -v93
    v_fma_f32 v46, v46, s60, -v93
    v_fma_f32 v47, v47, s60, -v93
    v_fma_f32 v48, v48, s60, -v93
    v_fma_f32 v49, v49, s60, -v93
    v_fma_f32 v50, v50, s60, -v93
    v_fma_f32 v51, v51, s60, -v93
    v_fma_f32 v52, v52, s60, -v93
    v_fma_f32 v53, v53, s60, -v93
    v_fma_f32 v54, v54, s60, -v93
    v_fma_f32 v55, v55, s60, -v93
    v_fma_f32 v56, v56, s60, -v93
    v_fma_f32 v57, v57, s60, -v93
    v_fma_f32 v58, v58, s60, -v93
    v_fma_f32 v59, v59, s60, -v93
    v_fma_f32 v60, v60, s60, -v93
    v_fma_f32 v61, v61, s60, -v93
    v_fma_f32 v62, v62, s60, -v93
    v_fma_f32 v63, v63, s60, -v93
    v_fma_f32 v64, v64, s60, -v93
    v_fma_f32 v65, v65, s60, -v93
    v_fma_f32 v66, v66, s60, -v93
    v_fma_f32 v67, v67, s60, -v93
    v_fma_f32 v68, v68, s60, -v93
    v_fma_f32 v69, v69, s60, -v93
    v_fma_f32 v70, v70, s60, -v93
    v_fma_f32 v71, v71, s60, -v93
    v_fma_f32 v72, v72, s60, -v93
    v_fma_f32 v73, v73, s60, -v93
    v_fma_f32 v74, v74, s60, -v93
    v_fma_f32 v75, v75, s60, -v93
    v_exp_f32 v8, v8
    v_exp_f32 v9, v9
    v_exp_f32 v10, v10
    v_exp_f32 v11, v11
    v_exp_f32 v12, v12
    v_exp_f32 v13, v13
    v_exp_f32 v14, v14
    v_exp_f32 v15, v15
    v_exp_f32 v16, v16
    v_exp_f32 v17, v17
    v_exp_f32 v18, v18
    v_exp_f32 v19, v19
    v_exp_f32 v20, v20
    v_exp_f32 v21, v21
    v_exp_f32 v22, v22
    v_exp_f32 v23, v23
    v_exp_f32 v24, v24
    v_exp_f32 v25, v25
    v_exp_f32 v26, v26
    v_exp_f32 v27, v27
    v_exp_f32 v28, v28
    v_exp_f32 v29, v29
    v_exp_f32 v30, v30
    v_exp_f32 v31, v31
    v_exp_f32 v32, v32
    v_exp_f32 v33, v33
    v_exp_f32 v34, v34
    v_exp_f32 v35, v35
    v_exp_f32 v36, v36
    v_exp_f32 v37, v37
    v_exp_f32 v38, v38
    v_exp_f32 v39, v39
    v_exp_f32 v40, v40
    v_exp_f32 v41, v41
    v_exp_f32 v42, v42
    v_exp_f32 v43, v43
    v_exp_f32 v44, v44
    v_exp_f32 v45, v45
    v_exp_f32 v46, v46
    v_exp_f32 v47, v47
    v_exp_f32 v48, v48
    v_exp_f32 v49, v49
    v_exp_f32 v50, v50
    v_exp_f32 v51, v51
    v_exp_f32 v52, v52
    v_exp_f32 v53, v53
    v_exp_f32 v54, v54
    v_exp_f32 v55, v55
    v_exp_f32 v56, v56
    v_exp_f32 v57, v57
    v_exp_f32 v58, v58
    v_exp_f32 v59, v59
    v_exp_f32 v60, v60
    v_exp_f32 v61, v61
    v_exp_f32 v62, v62
    v_exp_f32 v63, v63
    v_exp_f32 v64, v64
    v_exp_f32 v65, v65
    v_exp_f32 v66, v66
    v_exp_f32 v67, v67
    v_exp_f32 v68, v68
    v_exp_f32 v69, v69
    v_exp_f32 v70, v70
    v_exp_f32 v71, v71
    v_exp_f32 v72, v72
    v_exp_f32 v73, v73
    v_exp_f32 v74, v74
    v_exp_f32 v75, v75
    s_nop 0
    v_add_f32 v94, v8, v9
    v_add_f32 v95, v10, v11
    v_add_f32 v94, v94, v12
    v_add_f32 v95, v95, v13
    v_add_f32 v94, v94, v14
    v_add_f32 v95, v95, v15
    v_add_f32 v94, v94, v16
    v_add_f32 v95, v95, v17
    v_add_f32 v94, v94, v18
    v_add_f32 v95, v95, v19
    v_add_f32 v94, v94, v20
    v_add_f32 v95, v95, v21
    v_add_f32 v94, v94, v22
    v_add_f32 v95, v95, v23
    v_add_f32 v94, v94, v24
    v_add_f32 v95, v95, v25
    v_add_f32 v94, v94, v26
    v_add_f32 v95, v95, v27
    v_add_f32 v94, v94, v28
    v_add_f32 v95, v95, v29
    v_add_f32 v94, v94, v30
    v_add_f32 v95, v95, v31
    v_add_f32 v94, v94, v32
    v_add_f32 v95, v95, v33
    v_add_f32 v94, v94, v34
    v_add_f32 v95, v95, v35
    v_add_f32 v94, v94, v36
    v_add_f32 v95, v95, v37
    v_add_f32 v94, v94, v38
    v_add_f32 v95, v95, v39
    v_add_f32 v94, v94, v40
    v_add_f32 v95, v95, v41
    v_add_f32 v94, v94, v42
    v_add_f32 v95, v95, v43
    v_add_f32 v94, v94, v44
    v_add_f32 v95, v95, v45
    v_add_f32 v94, v94, v46
    v_add_f32 v95, v95, v47
    v_add_f32 v94, v94, v48
    v_add_f32 v95, v95, v49
    v_add_f32 v94, v94, v50
    v_add_f32 v95, v95, v51
    v_add_f32 v94, v94, v52
    v_add_f32 v95, v95, v53
    v_add_f32 v94, v94, v54
    v_add_f32 v95, v95, v55
    v_add_f32 v94, v94, v56
    v_add_f32 v95, v95, v57
    v_add_f32 v94, v94, v58
    v_add_f32 v95, v95, v59
    v_add_f32 v94, v94, v60
    v_add_f32 v95, v95, v61
    v_add_f32 v94, v94, v62
    v_add_f32 v95, v95, v63
    v_add_f32 v94, v94, v64
    v_add_f32 v95, v95, v65
    v_add_f32 v94, v94, v66
    v_add_f32 v95, v95, v67
    v_add_f32 v94, v94, v68
    v_add_f32 v95, v95, v69
    v_add_f32 v94, v94, v70
    v_add_f32 v95, v95, v71
    v_add_f32 v94, v94, v72
    v_add_f32 v95, v95, v73
    v_add_f32 v94, v94, v74
    v_add_f32 v95, v95, v75
    v_add_f32 v94, v94, v95
    s_waitcnt vmcnt(15)
    v_lshlrev_b32 v84, 16, v116
    v_and_b32 v85, s61, v116
    v_lshlrev_b32 v86, 16, v117
    v_and_b32 v87, s61, v117
    v_lshlrev_b32 v88, 16, v118
    v_and_b32 v89, s61, v118
    v_lshlrev_b32 v90, 16, v119
    v_and_b32 v91, s61, v119
    s_mov_b32 s44, 16384
    buffer_load_dwordx4 v[116:119], v1, s[28:31], s44 offen offset:0 nt
    v_fmac_f32 v76, v8, v84
    v_fmac_f32 v77, v8, v85
    v_fmac_f32 v78, v8, v86
    v_fmac_f32 v79, v8, v87
    v_fmac_f32 v80, v8, v88
    v_fmac_f32 v81, v8, v89
    v_fmac_f32 v82, v8, v90
    v_fmac_f32 v83, v8, v91
    s_waitcnt vmcnt(15)
    v_lshlrev_b32 v84, 16, v120
    v_and_b32 v85, s61, v120
    v_lshlrev_b32 v86, 16, v121
    v_and_b32 v87, s61, v121
    v_lshlrev_b32 v88, 16, v122
    v_and_b32 v89, s61, v122
    v_lshlrev_b32 v90, 16, v123
    v_and_b32 v91, s61, v123
    s_mov_b32 s45, 16384
    buffer_load_dwordx4 v[120:123], v1, s[28:31], s45 offen offset:1024 nt
    v_fmac_f32 v76, v9, v84
    v_fmac_f32 v77, v9, v85
    v_fmac_f32 v78, v9, v86
    v_fmac_f32 v79, v9, v87
    v_fmac_f32 v80, v9, v88
    v_fmac_f32 v81, v9, v89
    v_fmac_f32 v82, v9, v90
    v_fmac_f32 v83, v9, v91
    s_waitcnt vmcnt(15)
    v_lshlrev_b32 v84, 16, v124
    v_and_b32 v85, s61, v124
    v_lshlrev_b32 v86, 16, v125
    v_and_b32 v87, s61, v125
    v_lshlrev_b32 v88, 16, v126
    v_and_b32 v89, s61, v126
    v_lshlrev_b32 v90, 16, v127
    v_and_b32 v91, s61, v127
    s_mov_b32 s46, 16384
    buffer_load_dwordx4 v[124:127], v1, s[28:31], s46 offen offset:2048 nt
    v_fmac_f32 v76, v10, v84
    v_fmac_f32 v77, v10, v85
    v_fmac_f32 v78, v10, v86
    v_fmac_f32 v79, v10, v87
    v_fmac_f32 v80, v10, v88
    v_fmac_f32 v81, v10, v89
    v_fmac_f32 v82, v10, v90
    v_fmac_f32 v83, v10, v91
    s_waitcnt vmcnt(15)
    v_lshlrev_b32 v84, 16, v128
    v_and_b32 v85, s61, v128
    v_lshlrev_b32 v86, 16, v129
    v_and_b32 v87, s61, v129
    v_lshlrev_b32 v88, 16, v130
    v_and_b32 v89, s61, v130
    v_lshlrev_b32 v90, 16, v131
    v_and_b32 v91, s61, v131
    s_mov_b32 s47, 16384
    buffer_load_dwordx4 v[128:131], v1, s[28:31], s47 offen offset:3072 nt
    v_fmac_f32 v76, v11, v84
    v_fmac_f32 v77, v11, v85
    v_fmac_f32 v78, v11, v86
    v_fmac_f32 v79, v11, v87
    v_fmac_f32 v80, v11, v88
    v_fmac_f32 v81, v11, v89
    v_fmac_f32 v82, v11, v90
    v_fmac_f32 v83, v11, v91
    s_waitcnt vmcnt(15)
    v_lshlrev_b32 v84, 16, v132
    v_and_b32 v85, s61, v132
    v_lshlrev_b32 v86, 16, v133
    v_and_b32 v87, s61, v133
    v_lshlrev_b32 v88, 16, v134
    v_and_b32 v89, s61, v134
    v_lshlrev_b32 v90, 16, v135
    v_and_b32 v91, s61, v135
    s_mov_b32 s40, 20480
    buffer_load_dwordx4 v[132:135], v1, s[28:31], s40 offen offset:0 nt
    v_fmac_f32 v76, v12, v84
    v_fmac_f32 v77, v12, v85
    v_fmac_f32 v78, v12, v86
    v_fmac_f32 v79, v12, v87
    v_fmac_f32 v80, v12, v88
    v_fmac_f32 v81, v12, v89
    v_fmac_f32 v82, v12, v90
    v_fmac_f32 v83, v12, v91
    s_waitcnt vmcnt(15)
    v_lshlrev_b32 v84, 16, v136
    v_and_b32 v85, s61, v136
    v_lshlrev_b32 v86, 16, v137
    v_and_b32 v87, s61, v137
    v_lshlrev_b32 v88, 16, v138
    v_and_b32 v89, s61, v138
    v_lshlrev_b32 v90, 16, v139
    v_and_b32 v91, s61, v139
    s_mov_b32 s41, 20480
    buffer_load_dwordx4 v[136:139], v1, s[28:31], s41 offen offset:1024 nt
    v_fmac_f32 v76, v13, v84
    v_fmac_f32 v77, v13, v85
    v_fmac_f32 v78, v13, v86
    v_fmac_f32 v79, v13, v87
    v_fmac_f32 v80, v13, v88
    v_fmac_f32 v81, v13, v89
    v_fmac_f32 v82, v13, v90
    v_fmac_f32 v83, v13, v91
    s_waitcnt vmcnt(15)
    v_lshlrev_b32 v84, 16, v140
    v_and_b32 v85, s61, v140
    v_lshlrev_b32 v86, 16, v141
    v_and_b32 v87, s61, v141
    v_lshlrev_b32 v88, 16, v142
    v_and_b32 v89, s61, v142
    v_lshlrev_b32 v90, 16, v143
    v_and_b32 v91, s61, v143
    s_mov_b32 s42, 20480
    buffer_load_dwordx4 v[140:143], v1, s[28:31], s42 offen offset:2048 nt
    v_fmac_f32 v76, v14, v84
    v_fmac_f32 v77, v14, v85
    v_fmac_f32 v78, v14, v86
    v_fmac_f32 v79, v14, v87
    v_fmac_f32 v80, v14, v88
    v_fmac_f32 v81, v14, v89
    v_fmac_f32 v82, v14, v90
    v_fmac_f32 v83, v14, v91
    s_waitcnt vmcnt(15)
    v_lshlrev_b32 v84, 16, v144
    v_and_b32 v85, s61, v144
    v_lshlrev_b32 v86, 16, v145
    v_and_b32 v87, s61, v145
    v_lshlrev_b32 v88, 16, v146
    v_and_b32 v89, s61, v146
    v_lshlrev_b32 v90, 16, v147
    v_and_b32 v91, s61, v147
    s_mov_b32 s43, 20480
    buffer_load_dwordx4 v[144:147], v1, s[28:31], s43 offen offset:3072 nt
    v_fmac_f32 v76, v15, v84
    v_fmac_f32 v77, v15, v85
    v_fmac_f32 v78, v15, v86
    v_fmac_f32 v79, v15, v87
    v_fmac_f32 v80, v15, v88
    v_fmac_f32 v81, v15, v89
    v_fmac_f32 v82, v15, v90
    v_fmac_f32 v83, v15, v91
    s_waitcnt vmcnt(15)
    v_lshlrev_b32 v84, 16, v148
    v_and_b32 v85, s61, v148
    v_lshlrev_b32 v86, 16, v149
    v_and_b32 v87, s61, v149
    v_lshlrev_b32 v88, 16, v150
    v_and_b32 v89, s61, v150
    v_lshlrev_b32 v90, 16, v151
    v_and_b32 v91, s61, v151
    s_mov_b32 s44, 24576
    buffer_load_dwordx4 v[148:151], v1, s[28:31], s44 offen offset:0 nt
    v_fmac_f32 v76, v16, v84
    v_fmac_f32 v77, v16, v85
    v_fmac_f32 v78, v16, v86
    v_fmac_f32 v79, v16, v87
    v_fmac_f32 v80, v16, v88
    v_fmac_f32 v81, v16, v89
    v_fmac_f32 v82, v16, v90
    v_fmac_f32 v83, v16, v91
    s_waitcnt vmcnt(15)
    v_lshlrev_b32 v84, 16, v152
    v_and_b32 v85, s61, v152
    v_lshlrev_b32 v86, 16, v153
    v_and_b32 v87, s61, v153
    v_lshlrev_b32 v88, 16, v154
    v_and_b32 v89, s61, v154
    v_lshlrev_b32 v90, 16, v155
    v_and_b32 v91, s61, v155
    s_mov_b32 s45, 24576
    buffer_load_dwordx4 v[152:155], v1, s[28:31], s45 offen offset:1024 nt
    v_fmac_f32 v76, v17, v84
    v_fmac_f32 v77, v17, v85
    v_fmac_f32 v78, v17, v86
    v_fmac_f32 v79, v17, v87
    v_fmac_f32 v80, v17, v88
    v_fmac_f32 v81, v17, v89
    v_fmac_f32 v82, v17, v90
    v_fmac_f32 v83, v17, v91
    s_waitcnt vmcnt(15)
    v_lshlrev_b32 v84, 16, v156
    v_and_b32 v85, s61, v156
    v_lshlrev_b32 v86, 16, v157
    v_and_b32 v87, s61, v157
    v_lshlrev_b32 v88, 16, v158
    v_and_b32 v89, s61, v158
    v_lshlrev_b32 v90, 16, v159
    v_and_b32 v91, s61, v159
    s_mov_b32 s46, 24576
    buffer_load_dwordx4 v[156:159], v1, s[28:31], s46 offen offset:2048 nt
    v_fmac_f32 v76, v18, v84
    v_fmac_f32 v77, v18, v85
    v_fmac_f32 v78, v18, v86
    v_fmac_f32 v79, v18, v87
    v_fmac_f32 v80, v18, v88
    v_fmac_f32 v81, v18, v89
    v_fmac_f32 v82, v18, v90
    v_fmac_f32 v83, v18, v91
    s_waitcnt vmcnt(15)
    v_lshlrev_b32 v84, 16, v160
    v_and_b32 v85, s61, v160
    v_lshlrev_b32 v86, 16, v161
    v_and_b32 v87, s61, v161
    v_lshlrev_b32 v88, 16, v162
    v_and_b32 v89, s61, v162
    v_lshlrev_b32 v90, 16, v163
    v_and_b32 v91, s61, v163
    s_mov_b32 s47, 24576
    buffer_load_dwordx4 v[160:163], v1, s[28:31], s47 offen offset:3072 nt
    v_fmac_f32 v76, v19, v84
    v_fmac_f32 v77, v19, v85
    v_fmac_f32 v78, v19, v86
    v_fmac_f32 v79, v19, v87
    v_fmac_f32 v80, v19, v88
    v_fmac_f32 v81, v19, v89
    v_fmac_f32 v82, v19, v90
    v_fmac_f32 v83, v19, v91
    s_waitcnt vmcnt(15)
    v_lshlrev_b32 v84, 16, v100
    v_and_b32 v85, s61, v100
    v_lshlrev_b32 v86, 16, v101
    v_and_b32 v87, s61, v101
    v_lshlrev_b32 v88, 16, v102
    v_and_b32 v89, s61, v102
    v_lshlrev_b32 v90, 16, v103
    v_and_b32 v91, s61, v103
    s_mov_b32 s40, 28672
    buffer_load_dwordx4 v[100:103], v1, s[28:31], s40 offen offset:0 nt
    v_fmac_f32 v76, v20, v84
    v_fmac_f32 v77, v20, v85
    v_fmac_f32 v78, v20, v86
    v_fmac_f32 v79, v20, v87
    v_fmac_f32 v80, v20, v88
    v_fmac_f32 v81, v20, v89
    v_fmac_f32 v82, v20, v90
    v_fmac_f32 v83, v20, v91
    s_waitcnt vmcnt(15)
    v_lshlrev_b32 v84, 16, v104
    v_and_b32 v85, s61, v104
    v_lshlrev_b32 v86, 16, v105
    v_and_b32 v87, s61, v105
    v_lshlrev_b32 v88, 16, v106
    v_and_b32 v89, s61, v106
    v_lshlrev_b32 v90, 16, v107
    v_and_b32 v91, s61, v107
    s_mov_b32 s41, 28672
    buffer_load_dwordx4 v[104:107], v1, s[28:31], s41 offen offset:1024 nt
    v_fmac_f32 v76, v21, v84
    v_fmac_f32 v77, v21, v85
    v_fmac_f32 v78, v21, v86
    v_fmac_f32 v79, v21, v87
    v_fmac_f32 v80, v21, v88
    v_fmac_f32 v81, v21, v89
    v_fmac_f32 v82, v21, v90
    v_fmac_f32 v83, v21, v91
    s_waitcnt vmcnt(15)
    v_lshlrev_b32 v84, 16, v108
    v_and_b32 v85, s61, v108
    v_lshlrev_b32 v86, 16, v109
    v_and_b32 v87, s61, v109
    v_lshlrev_b32 v88, 16, v110
    v_and_b32 v89, s61, v110
    v_lshlrev_b32 v90, 16, v111
    v_and_b32 v91, s61, v111
    s_mov_b32 s42, 28672
    buffer_load_dwordx4 v[108:111], v1, s[28:31], s42 offen offset:2048 nt
    v_fmac_f32 v76, v22, v84
    v_fmac_f32 v77, v22, v85
    v_fmac_f32 v78, v22, v86
    v_fmac_f32 v79, v22, v87
    v_fmac_f32 v80, v22, v88
    v_fmac_f32 v81, v22, v89
    v_fmac_f32 v82, v22, v90
    v_fmac_f32 v83, v22, v91
    s_waitcnt vmcnt(15)
    v_lshlrev_b32 v84, 16, v112
    v_and_b32 v85, s61, v112
    v_lshlrev_b32 v86, 16, v113
    v_and_b32 v87, s61, v113
    v_lshlrev_b32 v88, 16, v114
    v_and_b32 v89, s61, v114
    v_lshlrev_b32 v90, 16, v115
    v_and_b32 v91, s61, v115
    s_mov_b32 s43, 28672
    buffer_load_dwordx4 v[112:115], v1, s[28:31], s43 offen offset:3072 nt
    v_fmac_f32 v76, v23, v84
    v_fmac_f32 v77, v23, v85
    v_fmac_f32 v78, v23, v86
    v_fmac_f32 v79, v23, v87
    v_fmac_f32 v80, v23, v88
    v_fmac_f32 v81, v23, v89
    v_fmac_f32 v82, v23, v90
    v_fmac_f32 v83, v23, v91
    s_waitcnt vmcnt(15)
    v_lshlrev_b32 v84, 16, v116
    v_and_b32 v85, s61, v116
    v_lshlrev_b32 v86, 16, v117
    v_and_b32 v87, s61, v117
    v_lshlrev_b32 v88, 16, v118
    v_and_b32 v89, s61, v118
    v_lshlrev_b32 v90, 16, v119
    v_and_b32 v91, s61, v119
    s_mov_b32 s44, 32768
    buffer_load_dwordx4 v[116:119], v1, s[28:31], s44 offen offset:0 nt
    v_fmac_f32 v76, v24, v84
    v_fmac_f32 v77, v24, v85
    v_fmac_f32 v78, v24, v86
    v_fmac_f32 v79, v24, v87
    v_fmac_f32 v80, v24, v88
    v_fmac_f32 v81, v24, v89
    v_fmac_f32 v82, v24, v90
    v_fmac_f32 v83, v24, v91
    s_waitcnt vmcnt(15)
    v_lshlrev_b32 v84, 16, v120
    v_and_b32 v85, s61, v120
    v_lshlrev_b32 v86, 16, v121
    v_and_b32 v87, s61, v121
    v_lshlrev_b32 v88, 16, v122
    v_and_b32 v89, s61, v122
    v_lshlrev_b32 v90, 16, v123
    v_and_b32 v91, s61, v123
    s_mov_b32 s45, 32768
    buffer_load_dwordx4 v[120:123], v1, s[28:31], s45 offen offset:1024 nt
    v_fmac_f32 v76, v25, v84
    v_fmac_f32 v77, v25, v85
    v_fmac_f32 v78, v25, v86
    v_fmac_f32 v79, v25, v87
    v_fmac_f32 v80, v25, v88
    v_fmac_f32 v81, v25, v89
    v_fmac_f32 v82, v25, v90
    v_fmac_f32 v83, v25, v91
    s_waitcnt vmcnt(15)
    v_lshlrev_b32 v84, 16, v124
    v_and_b32 v85, s61, v124
    v_lshlrev_b32 v86, 16, v125
    v_and_b32 v87, s61, v125
    v_lshlrev_b32 v88, 16, v126
    v_and_b32 v89, s61, v126
    v_lshlrev_b32 v90, 16, v127
    v_and_b32 v91, s61, v127
    s_mov_b32 s46, 32768
    buffer_load_dwordx4 v[124:127], v1, s[28:31], s46 offen offset:2048 nt
    v_fmac_f32 v76, v26, v84
    v_fmac_f32 v77, v26, v85
    v_fmac_f32 v78, v26, v86
    v_fmac_f32 v79, v26, v87
    v_fmac_f32 v80, v26, v88
    v_fmac_f32 v81, v26, v89
    v_fmac_f32 v82, v26, v90
    v_fmac_f32 v83, v26, v91
    s_waitcnt vmcnt(15)
    v_lshlrev_b32 v84, 16, v128
    v_and_b32 v85, s61, v128
    v_lshlrev_b32 v86, 16, v129
    v_and_b32 v87, s61, v129
    v_lshlrev_b32 v88, 16, v130
    v_and_b32 v89, s61, v130
    v_lshlrev_b32 v90, 16, v131
    v_and_b32 v91, s61, v131
    s_mov_b32 s47, 32768
    buffer_load_dwordx4 v[128:131], v1, s[28:31], s47 offen offset:3072 nt
    v_fmac_f32 v76, v27, v84
    v_fmac_f32 v77, v27, v85
    v_fmac_f32 v78, v27, v86
    v_fmac_f32 v79, v27, v87
    v_fmac_f32 v80, v27, v88
    v_fmac_f32 v81, v27, v89
    v_fmac_f32 v82, v27, v90
    v_fmac_f32 v83, v27, v91
    s_waitcnt vmcnt(15)
    v_lshlrev_b32 v84, 16, v132
    v_and_b32 v85, s61, v132
    v_lshlrev_b32 v86, 16, v133
    v_and_b32 v87, s61, v133
    v_lshlrev_b32 v88, 16, v134
    v_and_b32 v89, s61, v134
    v_lshlrev_b32 v90, 16, v135
    v_and_b32 v91, s61, v135
    s_mov_b32 s40, 36864
    buffer_load_dwordx4 v[132:135], v1, s[28:31], s40 offen offset:0 nt
    v_fmac_f32 v76, v28, v84
    v_fmac_f32 v77, v28, v85
    v_fmac_f32 v78, v28, v86
    v_fmac_f32 v79, v28, v87
    v_fmac_f32 v80, v28, v88
    v_fmac_f32 v81, v28, v89
    v_fmac_f32 v82, v28, v90
    v_fmac_f32 v83, v28, v91
    s_waitcnt vmcnt(15)
    v_lshlrev_b32 v84, 16, v136
    v_and_b32 v85, s61, v136
    v_lshlrev_b32 v86, 16, v137
    v_and_b32 v87, s61, v137
    v_lshlrev_b32 v88, 16, v138
    v_and_b32 v89, s61, v138
    v_lshlrev_b32 v90, 16, v139
    v_and_b32 v91, s61, v139
    s_mov_b32 s41, 36864
    buffer_load_dwordx4 v[136:139], v1, s[28:31], s41 offen offset:1024 nt
    v_fmac_f32 v76, v29, v84
    v_fmac_f32 v77, v29, v85
    v_fmac_f32 v78, v29, v86
    v_fmac_f32 v79, v29, v87
    v_fmac_f32 v80, v29, v88
    v_fmac_f32 v81, v29, v89
    v_fmac_f32 v82, v29, v90
    v_fmac_f32 v83, v29, v91
    s_waitcnt vmcnt(15)
    v_lshlrev_b32 v84, 16, v140
    v_and_b32 v85, s61, v140
    v_lshlrev_b32 v86, 16, v141
    v_and_b32 v87, s61, v141
    v_lshlrev_b32 v88, 16, v142
    v_and_b32 v89, s61, v142
    v_lshlrev_b32 v90, 16, v143
    v_and_b32 v91, s61, v143
    s_mov_b32 s42, 36864
    buffer_load_dwordx4 v[140:143], v1, s[28:31], s42 offen offset:2048 nt
    v_fmac_f32 v76, v30, v84
    v_fmac_f32 v77, v30, v85
    v_fmac_f32 v78, v30, v86
    v_fmac_f32 v79, v30, v87
    v_fmac_f32 v80, v30, v88
    v_fmac_f32 v81, v30, v89
    v_fmac_f32 v82, v30, v90
    v_fmac_f32 v83, v30, v91
    s_waitcnt vmcnt(15)
    v_lshlrev_b32 v84, 16, v144
    v_and_b32 v85, s61, v144
    v_lshlrev_b32 v86, 16, v145
    v_and_b32 v87, s61, v145
    v_lshlrev_b32 v88, 16, v146
    v_and_b32 v89, s61, v146
    v_lshlrev_b32 v90, 16, v147
    v_and_b32 v91, s61, v147
    s_mov_b32 s43, 36864
    buffer_load_dwordx4 v[144:147], v1, s[28:31], s43 offen offset:3072 nt
    v_fmac_f32 v76, v31, v84
    v_fmac_f32 v77, v31, v85
    v_fmac_f32 v78, v31, v86
    v_fmac_f32 v79, v31, v87
    v_fmac_f32 v80, v31, v88
    v_fmac_f32 v81, v31, v89
    v_fmac_f32 v82, v31, v90
    v_fmac_f32 v83, v31, v91
    s_waitcnt vmcnt(15)
    v_lshlrev_b32 v84, 16, v148
    v_and_b32 v85, s61, v148
    v_lshlrev_b32 v86, 16, v149
    v_and_b32 v87, s61, v149
    v_lshlrev_b32 v88, 16, v150
    v_and_b32 v89, s61, v150
    v_lshlrev_b32 v90, 16, v151
    v_and_b32 v91, s61, v151
    s_mov_b32 s44, 40960
    buffer_load_dwordx4 v[148:151], v1, s[28:31], s44 offen offset:0 nt
    v_fmac_f32 v76, v32, v84
    v_fmac_f32 v77, v32, v85
    v_fmac_f32 v78, v32, v86
    v_fmac_f32 v79, v32, v87
    v_fmac_f32 v80, v32, v88
    v_fmac_f32 v81, v32, v89
    v_fmac_f32 v82, v32, v90
    v_fmac_f32 v83, v32, v91
    s_waitcnt vmcnt(15)
    v_lshlrev_b32 v84, 16, v152
    v_and_b32 v85, s61, v152
    v_lshlrev_b32 v86, 16, v153
    v_and_b32 v87, s61, v153
    v_lshlrev_b32 v88, 16, v154
    v_and_b32 v89, s61, v154
    v_lshlrev_b32 v90, 16, v155
    v_and_b32 v91, s61, v155
    s_mov_b32 s45, 40960
    buffer_load_dwordx4 v[152:155], v1, s[28:31], s45 offen offset:1024 nt
    v_fmac_f32 v76, v33, v84
    v_fmac_f32 v77, v33, v85
    v_fmac_f32 v78, v33, v86
    v_fmac_f32 v79, v33, v87
    v_fmac_f32 v80, v33, v88
    v_fmac_f32 v81, v33, v89
    v_fmac_f32 v82, v33, v90
    v_fmac_f32 v83, v33, v91
    s_waitcnt vmcnt(15)
    v_lshlrev_b32 v84, 16, v156
    v_and_b32 v85, s61, v156
    v_lshlrev_b32 v86, 16, v157
    v_and_b32 v87, s61, v157
    v_lshlrev_b32 v88, 16, v158
    v_and_b32 v89, s61, v158
    v_lshlrev_b32 v90, 16, v159
    v_and_b32 v91, s61, v159
    s_mov_b32 s46, 40960
    buffer_load_dwordx4 v[156:159], v1, s[28:31], s46 offen offset:2048 nt
    v_fmac_f32 v76, v34, v84
    v_fmac_f32 v77, v34, v85
    v_fmac_f32 v78, v34, v86
    v_fmac_f32 v79, v34, v87
    v_fmac_f32 v80, v34, v88
    v_fmac_f32 v81, v34, v89
    v_fmac_f32 v82, v34, v90
    v_fmac_f32 v83, v34, v91
    s_waitcnt vmcnt(15)
    v_lshlrev_b32 v84, 16, v160
    v_and_b32 v85, s61, v160
    v_lshlrev_b32 v86, 16, v161
    v_and_b32 v87, s61, v161
    v_lshlrev_b32 v88, 16, v162
    v_and_b32 v89, s61, v162
    v_lshlrev_b32 v90, 16, v163
    v_and_b32 v91, s61, v163
    s_mov_b32 s47, 40960
    buffer_load_dwordx4 v[160:163], v1, s[28:31], s47 offen offset:3072 nt
    v_fmac_f32 v76, v35, v84
    v_fmac_f32 v77, v35, v85
    v_fmac_f32 v78, v35, v86
    v_fmac_f32 v79, v35, v87
    v_fmac_f32 v80, v35, v88
    v_fmac_f32 v81, v35, v89
    v_fmac_f32 v82, v35, v90
    v_fmac_f32 v83, v35, v91
    s_waitcnt vmcnt(15)
    v_lshlrev_b32 v84, 16, v100
    v_and_b32 v85, s61, v100
    v_lshlrev_b32 v86, 16, v101
    v_and_b32 v87, s61, v101
    v_lshlrev_b32 v88, 16, v102
    v_and_b32 v89, s61, v102
    v_lshlrev_b32 v90, 16, v103
    v_and_b32 v91, s61, v103
    s_mov_b32 s40, 45056
    buffer_load_dwordx4 v[100:103], v1, s[28:31], s40 offen offset:0 nt
    v_fmac_f32 v76, v36, v84
    v_fmac_f32 v77, v36, v85
    v_fmac_f32 v78, v36, v86
    v_fmac_f32 v79, v36, v87
    v_fmac_f32 v80, v36, v88
    v_fmac_f32 v81, v36, v89
    v_fmac_f32 v82, v36, v90
    v_fmac_f32 v83, v36, v91
    s_waitcnt vmcnt(15)
    v_lshlrev_b32 v84, 16, v104
    v_and_b32 v85, s61, v104
    v_lshlrev_b32 v86, 16, v105
    v_and_b32 v87, s61, v105
    v_lshlrev_b32 v88, 16, v106
    v_and_b32 v89, s61, v106
    v_lshlrev_b32 v90, 16, v107
    v_and_b32 v91, s61, v107
    s_mov_b32 s41, 45056
    buffer_load_dwordx4 v[104:107], v1, s[28:31], s41 offen offset:1024 nt
    v_fmac_f32 v76, v37, v84
    v_fmac_f32 v77, v37, v85
    v_fmac_f32 v78, v37, v86
    v_fmac_f32 v79, v37, v87
    v_fmac_f32 v80, v37, v88
    v_fmac_f32 v81, v37, v89
    v_fmac_f32 v82, v37, v90
    v_fmac_f32 v83, v37, v91
    s_waitcnt vmcnt(15)
    v_lshlrev_b32 v84, 16, v108
    v_and_b32 v85, s61, v108
    v_lshlrev_b32 v86, 16, v109
    v_and_b32 v87, s61, v109
    v_lshlrev_b32 v88, 16, v110
    v_and_b32 v89, s61, v110
    v_lshlrev_b32 v90, 16, v111
    v_and_b32 v91, s61, v111
    s_mov_b32 s42, 45056
    buffer_load_dwordx4 v[108:111], v1, s[28:31], s42 offen offset:2048 nt
    v_fmac_f32 v76, v38, v84
    v_fmac_f32 v77, v38, v85
    v_fmac_f32 v78, v38, v86
    v_fmac_f32 v79, v38, v87
    v_fmac_f32 v80, v38, v88
    v_fmac_f32 v81, v38, v89
    v_fmac_f32 v82, v38, v90
    v_fmac_f32 v83, v38, v91
    s_waitcnt vmcnt(15)
    v_lshlrev_b32 v84, 16, v112
    v_and_b32 v85, s61, v112
    v_lshlrev_b32 v86, 16, v113
    v_and_b32 v87, s61, v113
    v_lshlrev_b32 v88, 16, v114
    v_and_b32 v89, s61, v114
    v_lshlrev_b32 v90, 16, v115
    v_and_b32 v91, s61, v115
    s_mov_b32 s43, 45056
    buffer_load_dwordx4 v[112:115], v1, s[28:31], s43 offen offset:3072 nt
    v_fmac_f32 v76, v39, v84
    v_fmac_f32 v77, v39, v85
    v_fmac_f32 v78, v39, v86
    v_fmac_f32 v79, v39, v87
    v_fmac_f32 v80, v39, v88
    v_fmac_f32 v81, v39, v89
    v_fmac_f32 v82, v39, v90
    v_fmac_f32 v83, v39, v91
    s_waitcnt vmcnt(15)
    v_lshlrev_b32 v84, 16, v116
    v_and_b32 v85, s61, v116
    v_lshlrev_b32 v86, 16, v117
    v_and_b32 v87, s61, v117
    v_lshlrev_b32 v88, 16, v118
    v_and_b32 v89, s61, v118
    v_lshlrev_b32 v90, 16, v119
    v_and_b32 v91, s61, v119
    s_mov_b32 s44, 49152
    buffer_load_dwordx4 v[116:119], v1, s[28:31], s44 offen offset:0 nt
    v_fmac_f32 v76, v40, v84
    v_fmac_f32 v77, v40, v85
    v_fmac_f32 v78, v40, v86
    v_fmac_f32 v79, v40, v87
    v_fmac_f32 v80, v40, v88
    v_fmac_f32 v81, v40, v89
    v_fmac_f32 v82, v40, v90
    v_fmac_f32 v83, v40, v91
    s_waitcnt vmcnt(15)
    v_lshlrev_b32 v84, 16, v120
    v_and_b32 v85, s61, v120
    v_lshlrev_b32 v86, 16, v121
    v_and_b32 v87, s61, v121
    v_lshlrev_b32 v88, 16, v122
    v_and_b32 v89, s61, v122
    v_lshlrev_b32 v90, 16, v123
    v_and_b32 v91, s61, v123
    s_mov_b32 s45, 49152
    buffer_load_dwordx4 v[120:123], v1, s[28:31], s45 offen offset:1024 nt
    v_fmac_f32 v76, v41, v84
    v_fmac_f32 v77, v41, v85
    v_fmac_f32 v78, v41, v86
    v_fmac_f32 v79, v41, v87
    v_fmac_f32 v80, v41, v88
    v_fmac_f32 v81, v41, v89
    v_fmac_f32 v82, v41, v90
    v_fmac_f32 v83, v41, v91
    s_waitcnt vmcnt(15)
    v_lshlrev_b32 v84, 16, v124
    v_and_b32 v85, s61, v124
    v_lshlrev_b32 v86, 16, v125
    v_and_b32 v87, s61, v125
    v_lshlrev_b32 v88, 16, v126
    v_and_b32 v89, s61, v126
    v_lshlrev_b32 v90, 16, v127
    v_and_b32 v91, s61, v127
    s_mov_b32 s46, 49152
    buffer_load_dwordx4 v[124:127], v1, s[28:31], s46 offen offset:2048 nt
    v_fmac_f32 v76, v42, v84
    v_fmac_f32 v77, v42, v85
    v_fmac_f32 v78, v42, v86
    v_fmac_f32 v79, v42, v87
    v_fmac_f32 v80, v42, v88
    v_fmac_f32 v81, v42, v89
    v_fmac_f32 v82, v42, v90
    v_fmac_f32 v83, v42, v91
    s_waitcnt vmcnt(15)
    v_lshlrev_b32 v84, 16, v128
    v_and_b32 v85, s61, v128
    v_lshlrev_b32 v86, 16, v129
    v_and_b32 v87, s61, v129
    v_lshlrev_b32 v88, 16, v130
    v_and_b32 v89, s61, v130
    v_lshlrev_b32 v90, 16, v131
    v_and_b32 v91, s61, v131
    s_mov_b32 s47, 49152
    buffer_load_dwordx4 v[128:131], v1, s[28:31], s47 offen offset:3072 nt
    v_fmac_f32 v76, v43, v84
    v_fmac_f32 v77, v43, v85
    v_fmac_f32 v78, v43, v86
    v_fmac_f32 v79, v43, v87
    v_fmac_f32 v80, v43, v88
    v_fmac_f32 v81, v43, v89
    v_fmac_f32 v82, v43, v90
    v_fmac_f32 v83, v43, v91
    s_waitcnt vmcnt(15)
    v_lshlrev_b32 v84, 16, v132
    v_and_b32 v85, s61, v132
    v_lshlrev_b32 v86, 16, v133
    v_and_b32 v87, s61, v133
    v_lshlrev_b32 v88, 16, v134
    v_and_b32 v89, s61, v134
    v_lshlrev_b32 v90, 16, v135
    v_and_b32 v91, s61, v135
    s_mov_b32 s40, 53248
    buffer_load_dwordx4 v[132:135], v1, s[28:31], s40 offen offset:0 nt
    v_fmac_f32 v76, v44, v84
    v_fmac_f32 v77, v44, v85
    v_fmac_f32 v78, v44, v86
    v_fmac_f32 v79, v44, v87
    v_fmac_f32 v80, v44, v88
    v_fmac_f32 v81, v44, v89
    v_fmac_f32 v82, v44, v90
    v_fmac_f32 v83, v44, v91
    s_waitcnt vmcnt(15)
    v_lshlrev_b32 v84, 16, v136
    v_and_b32 v85, s61, v136
    v_lshlrev_b32 v86, 16, v137
    v_and_b32 v87, s61, v137
    v_lshlrev_b32 v88, 16, v138
    v_and_b32 v89, s61, v138
    v_lshlrev_b32 v90, 16, v139
    v_and_b32 v91, s61, v139
    s_mov_b32 s41, 53248
    buffer_load_dwordx4 v[136:139], v1, s[28:31], s41 offen offset:1024 nt
    v_fmac_f32 v76, v45, v84
    v_fmac_f32 v77, v45, v85
    v_fmac_f32 v78, v45, v86
    v_fmac_f32 v79, v45, v87
    v_fmac_f32 v80, v45, v88
    v_fmac_f32 v81, v45, v89
    v_fmac_f32 v82, v45, v90
    v_fmac_f32 v83, v45, v91
    s_waitcnt vmcnt(15)
    v_lshlrev_b32 v84, 16, v140
    v_and_b32 v85, s61, v140
    v_lshlrev_b32 v86, 16, v141
    v_and_b32 v87, s61, v141
    v_lshlrev_b32 v88, 16, v142
    v_and_b32 v89, s61, v142
    v_lshlrev_b32 v90, 16, v143
    v_and_b32 v91, s61, v143
    s_mov_b32 s42, 53248
    buffer_load_dwordx4 v[140:143], v1, s[28:31], s42 offen offset:2048 nt
    v_fmac_f32 v76, v46, v84
    v_fmac_f32 v77, v46, v85
    v_fmac_f32 v78, v46, v86
    v_fmac_f32 v79, v46, v87
    v_fmac_f32 v80, v46, v88
    v_fmac_f32 v81, v46, v89
    v_fmac_f32 v82, v46, v90
    v_fmac_f32 v83, v46, v91
    s_waitcnt vmcnt(15)
    v_lshlrev_b32 v84, 16, v144
    v_and_b32 v85, s61, v144
    v_lshlrev_b32 v86, 16, v145
    v_and_b32 v87, s61, v145
    v_lshlrev_b32 v88, 16, v146
    v_and_b32 v89, s61, v146
    v_lshlrev_b32 v90, 16, v147
    v_and_b32 v91, s61, v147
    s_mov_b32 s43, 53248
    buffer_load_dwordx4 v[144:147], v1, s[28:31], s43 offen offset:3072 nt
    v_fmac_f32 v76, v47, v84
    v_fmac_f32 v77, v47, v85
    v_fmac_f32 v78, v47, v86
    v_fmac_f32 v79, v47, v87
    v_fmac_f32 v80, v47, v88
    v_fmac_f32 v81, v47, v89
    v_fmac_f32 v82, v47, v90
    v_fmac_f32 v83, v47, v91
    s_waitcnt vmcnt(15)
    v_lshlrev_b32 v84, 16, v148
    v_and_b32 v85, s61, v148
    v_lshlrev_b32 v86, 16, v149
    v_and_b32 v87, s61, v149
    v_lshlrev_b32 v88, 16, v150
    v_and_b32 v89, s61, v150
    v_lshlrev_b32 v90, 16, v151
    v_and_b32 v91, s61, v151
    s_mov_b32 s44, 57344
    buffer_load_dwordx4 v[148:151], v1, s[28:31], s44 offen offset:0 nt
    v_fmac_f32 v76, v48, v84
    v_fmac_f32 v77, v48, v85
    v_fmac_f32 v78, v48, v86
    v_fmac_f32 v79, v48, v87
    v_fmac_f32 v80, v48, v88
    v_fmac_f32 v81, v48, v89
    v_fmac_f32 v82, v48, v90
    v_fmac_f32 v83, v48, v91
    s_waitcnt vmcnt(15)
    v_lshlrev_b32 v84, 16, v152
    v_and_b32 v85, s61, v152
    v_lshlrev_b32 v86, 16, v153
    v_and_b32 v87, s61, v153
    v_lshlrev_b32 v88, 16, v154
    v_and_b32 v89, s61, v154
    v_lshlrev_b32 v90, 16, v155
    v_and_b32 v91, s61, v155
    s_mov_b32 s45, 57344
    buffer_load_dwordx4 v[152:155], v1, s[28:31], s45 offen offset:1024 nt
    v_fmac_f32 v76, v49, v84
    v_fmac_f32 v77, v49, v85
    v_fmac_f32 v78, v49, v86
    v_fmac_f32 v79, v49, v87
    v_fmac_f32 v80, v49, v88
    v_fmac_f32 v81, v49, v89
    v_fmac_f32 v82, v49, v90
    v_fmac_f32 v83, v49, v91
    s_waitcnt vmcnt(15)
    v_lshlrev_b32 v84, 16, v156
    v_and_b32 v85, s61, v156
    v_lshlrev_b32 v86, 16, v157
    v_and_b32 v87, s61, v157
    v_lshlrev_b32 v88, 16, v158
    v_and_b32 v89, s61, v158
    v_lshlrev_b32 v90, 16, v159
    v_and_b32 v91, s61, v159
    s_mov_b32 s46, 57344
    buffer_load_dwordx4 v[156:159], v1, s[28:31], s46 offen offset:2048 nt
    v_fmac_f32 v76, v50, v84
    v_fmac_f32 v77, v50, v85
    v_fmac_f32 v78, v50, v86
    v_fmac_f32 v79, v50, v87
    v_fmac_f32 v80, v50, v88
    v_fmac_f32 v81, v50, v89
    v_fmac_f32 v82, v50, v90
    v_fmac_f32 v83, v50, v91
    s_waitcnt vmcnt(15)
    v_lshlrev_b32 v84, 16, v160
    v_and_b32 v85, s61, v160
    v_lshlrev_b32 v86, 16, v161
    v_and_b32 v87, s61, v161
    v_lshlrev_b32 v88, 16, v162
    v_and_b32 v89, s61, v162
    v_lshlrev_b32 v90, 16, v163
    v_and_b32 v91, s61, v163
    s_mov_b32 s47, 57344
    buffer_load_dwordx4 v[160:163], v1, s[28:31], s47 offen offset:3072 nt
    v_fmac_f32 v76, v51, v84
    v_fmac_f32 v77, v51, v85
    v_fmac_f32 v78, v51, v86
    v_fmac_f32 v79, v51, v87
    v_fmac_f32 v80, v51, v88
    v_fmac_f32 v81, v51, v89
    v_fmac_f32 v82, v51, v90
    v_fmac_f32 v83, v51, v91
    s_waitcnt vmcnt(15)
    v_lshlrev_b32 v84, 16, v100
    v_and_b32 v85, s61, v100
    v_lshlrev_b32 v86, 16, v101
    v_and_b32 v87, s61, v101
    v_lshlrev_b32 v88, 16, v102
    v_and_b32 v89, s61, v102
    v_lshlrev_b32 v90, 16, v103
    v_and_b32 v91, s61, v103
    buffer_load_dwordx4 v[100:103], v2, s[28:31], 0 offen offset:0 nt
    v_fmac_f32 v76, v52, v84
    v_fmac_f32 v77, v52, v85
    v_fmac_f32 v78, v52, v86
    v_fmac_f32 v79, v52, v87
    v_fmac_f32 v80, v52, v88
    v_fmac_f32 v81, v52, v89
    v_fmac_f32 v82, v52, v90
    v_fmac_f32 v83, v52, v91
    s_waitcnt vmcnt(15)
    v_lshlrev_b32 v84, 16, v104
    v_and_b32 v85, s61, v104
    v_lshlrev_b32 v86, 16, v105
    v_and_b32 v87, s61, v105
    v_lshlrev_b32 v88, 16, v106
    v_and_b32 v89, s61, v106
    v_lshlrev_b32 v90, 16, v107
    v_and_b32 v91, s61, v107
    buffer_load_dwordx4 v[104:107], v2, s[28:31], 0 offen offset:1024 nt
    v_fmac_f32 v76, v53, v84
    v_fmac_f32 v77, v53, v85
    v_fmac_f32 v78, v53, v86
    v_fmac_f32 v79, v53, v87
    v_fmac_f32 v80, v53, v88
    v_fmac_f32 v81, v53, v89
    v_fmac_f32 v82, v53, v90
    v_fmac_f32 v83, v53, v91
    s_waitcnt vmcnt(15)
    v_lshlrev_b32 v84, 16, v108
    v_and_b32 v85, s61, v108
    v_lshlrev_b32 v86, 16, v109
    v_and_b32 v87, s61, v109
    v_lshlrev_b32 v88, 16, v110
    v_and_b32 v89, s61, v110
    v_lshlrev_b32 v90, 16, v111
    v_and_b32 v91, s61, v111
    buffer_load_dwordx4 v[108:111], v2, s[28:31], 0 offen offset:2048 nt
    v_fmac_f32 v76, v54, v84
    v_fmac_f32 v77, v54, v85
    v_fmac_f32 v78, v54, v86
    v_fmac_f32 v79, v54, v87
    v_fmac_f32 v80, v54, v88
    v_fmac_f32 v81, v54, v89
    v_fmac_f32 v82, v54, v90
    v_fmac_f32 v83, v54, v91
    s_waitcnt vmcnt(15)
    v_lshlrev_b32 v84, 16, v112
    v_and_b32 v85, s61, v112
    v_lshlrev_b32 v86, 16, v113
    v_and_b32 v87, s61, v113
    v_lshlrev_b32 v88, 16, v114
    v_and_b32 v89, s61, v114
    v_lshlrev_b32 v90, 16, v115
    v_and_b32 v91, s61, v115
    buffer_load_dwordx4 v[112:115], v2, s[28:31], 0 offen offset:3072 nt
    v_fmac_f32 v76, v55, v84
    v_fmac_f32 v77, v55, v85
    v_fmac_f32 v78, v55, v86
    v_fmac_f32 v79, v55, v87
    v_fmac_f32 v80, v55, v88
    v_fmac_f32 v81, v55, v89
    v_fmac_f32 v82, v55, v90
    v_fmac_f32 v83, v55, v91
    s_waitcnt vmcnt(15)
    v_lshlrev_b32 v84, 16, v116
    v_and_b32 v85, s61, v116
    v_lshlrev_b32 v86, 16, v117
    v_and_b32 v87, s61, v117
    v_lshlrev_b32 v88, 16, v118
    v_and_b32 v89, s61, v118
    v_lshlrev_b32 v90, 16, v119
    v_and_b32 v91, s61, v119
    s_mov_b32 s44, 4096
    buffer_load_dwordx4 v[116:119], v2, s[28:31], s44 offen offset:0 nt
    v_fmac_f32 v76, v56, v84
    v_fmac_f32 v77, v56, v85
    v_fmac_f32 v78, v56, v86
    v_fmac_f32 v79, v56, v87
    v_fmac_f32 v80, v56, v88
    v_fmac_f32 v81, v56, v89
    v_fmac_f32 v82, v56, v90
    v_fmac_f32 v83, v56, v91
    s_waitcnt vmcnt(15)
    v_lshlrev_b32 v84, 16, v120
    v_and_b32 v85, s61, v120
    v_lshlrev_b32 v86, 16, v121
    v_and_b32 v87, s61, v121
    v_lshlrev_b32 v88, 16, v122
    v_and_b32 v89, s61, v122
    v_lshlrev_b32 v90, 16, v123
    v_and_b32 v91, s61, v123
    s_mov_b32 s45, 4096
    buffer_load_dwordx4 v[120:123], v2, s[28:31], s45 offen offset:1024 nt
    v_fmac_f32 v76, v57, v84
    v_fmac_f32 v77, v57, v85
    v_fmac_f32 v78, v57, v86
    v_fmac_f32 v79, v57, v87
    v_fmac_f32 v80, v57, v88
    v_fmac_f32 v81, v57, v89
    v_fmac_f32 v82, v57, v90
    v_fmac_f32 v83, v57, v91
    s_waitcnt vmcnt(15)
    v_lshlrev_b32 v84, 16, v124
    v_and_b32 v85, s61, v124
    v_lshlrev_b32 v86, 16, v125
    v_and_b32 v87, s61, v125
    v_lshlrev_b32 v88, 16, v126
    v_and_b32 v89, s61, v126
    v_lshlrev_b32 v90, 16, v127
    v_and_b32 v91, s61, v127
    s_mov_b32 s46, 4096
    buffer_load_dwordx4 v[124:127], v2, s[28:31], s46 offen offset:2048 nt
    v_fmac_f32 v76, v58, v84
    v_fmac_f32 v77, v58, v85
    v_fmac_f32 v78, v58, v86
    v_fmac_f32 v79, v58, v87
    v_fmac_f32 v80, v58, v88
    v_fmac_f32 v81, v58, v89
    v_fmac_f32 v82, v58, v90
    v_fmac_f32 v83, v58, v91
    s_waitcnt vmcnt(15)
    v_lshlrev_b32 v84, 16, v128
    v_and_b32 v85, s61, v128
    v_lshlrev_b32 v86, 16, v129
    v_and_b32 v87, s61, v129
    v_lshlrev_b32 v88, 16, v130
    v_and_b32 v89, s61, v130
    v_lshlrev_b32 v90, 16, v131
    v_and_b32 v91, s61, v131
    s_mov_b32 s47, 4096
    buffer_load_dwordx4 v[128:131], v2, s[28:31], s47 offen offset:3072 nt
    v_fmac_f32 v76, v59, v84
    v_fmac_f32 v77, v59, v85
    v_fmac_f32 v78, v59, v86
    v_fmac_f32 v79, v59, v87
    v_fmac_f32 v80, v59, v88
    v_fmac_f32 v81, v59, v89
    v_fmac_f32 v82, v59, v90
    v_fmac_f32 v83, v59, v91
    s_waitcnt vmcnt(15)
    v_lshlrev_b32 v84, 16, v132
    v_and_b32 v85, s61, v132
    v_lshlrev_b32 v86, 16, v133
    v_and_b32 v87, s61, v133
    v_lshlrev_b32 v88, 16, v134
    v_and_b32 v89, s61, v134
    v_lshlrev_b32 v90, 16, v135
    v_and_b32 v91, s61, v135
    v_fmac_f32 v76, v60, v84
    v_fmac_f32 v77, v60, v85
    v_fmac_f32 v78, v60, v86
    v_fmac_f32 v79, v60, v87
    v_fmac_f32 v80, v60, v88
    v_fmac_f32 v81, v60, v89
    v_fmac_f32 v82, v60, v90
    v_fmac_f32 v83, v60, v91
    s_waitcnt vmcnt(14)
    v_lshlrev_b32 v84, 16, v136
    v_and_b32 v85, s61, v136
    v_lshlrev_b32 v86, 16, v137
    v_and_b32 v87, s61, v137
    v_lshlrev_b32 v88, 16, v138
    v_and_b32 v89, s61, v138
    v_lshlrev_b32 v90, 16, v139
    v_and_b32 v91, s61, v139
    v_fmac_f32 v76, v61, v84
    v_fmac_f32 v77, v61, v85
    v_fmac_f32 v78, v61, v86
    v_fmac_f32 v79, v61, v87
    v_fmac_f32 v80, v61, v88
    v_fmac_f32 v81, v61, v89
    v_fmac_f32 v82, v61, v90
    v_fmac_f32 v83, v61, v91
    s_waitcnt vmcnt(13)
    v_lshlrev_b32 v84, 16, v140
    v_and_b32 v85, s61, v140
    v_lshlrev_b32 v86, 16, v141
    v_and_b32 v87, s61, v141
    v_lshlrev_b32 v88, 16, v142
    v_and_b32 v89, s61, v142
    v_lshlrev_b32 v90, 16, v143
    v_and_b32 v91, s61, v143
    v_fmac_f32 v76, v62, v84
    v_fmac_f32 v77, v62, v85
    v_fmac_f32 v78, v62, v86
    v_fmac_f32 v79, v62, v87
    v_fmac_f32 v80, v62, v88
    v_fmac_f32 v81, v62, v89
    v_fmac_f32 v82, v62, v90
    v_fmac_f32 v83, v62, v91
    s_waitcnt vmcnt(12)
    v_lshlrev_b32 v84, 16, v144
    v_and_b32 v85, s61, v144
    v_lshlrev_b32 v86, 16, v145
    v_and_b32 v87, s61, v145
    v_lshlrev_b32 v88, 16, v146
    v_and_b32 v89, s61, v146
    v_lshlrev_b32 v90, 16, v147
    v_and_b32 v91, s61, v147
    v_fmac_f32 v76, v63, v84
    v_fmac_f32 v77, v63, v85
    v_fmac_f32 v78, v63, v86
    v_fmac_f32 v79, v63, v87
    v_fmac_f32 v80, v63, v88
    v_fmac_f32 v81, v63, v89
    v_fmac_f32 v82, v63, v90
    v_fmac_f32 v83, v63, v91
    s_waitcnt vmcnt(11)
    v_lshlrev_b32 v84, 16, v148
    v_and_b32 v85, s61, v148
    v_lshlrev_b32 v86, 16, v149
    v_and_b32 v87, s61, v149
    v_lshlrev_b32 v88, 16, v150
    v_and_b32 v89, s61, v150
    v_lshlrev_b32 v90, 16, v151
    v_and_b32 v91, s61, v151
    v_fmac_f32 v76, v64, v84
    v_fmac_f32 v77, v64, v85
    v_fmac_f32 v78, v64, v86
    v_fmac_f32 v79, v64, v87
    v_fmac_f32 v80, v64, v88
    v_fmac_f32 v81, v64, v89
    v_fmac_f32 v82, v64, v90
    v_fmac_f32 v83, v64, v91
    s_waitcnt vmcnt(10)
    v_lshlrev_b32 v84, 16, v152
    v_and_b32 v85, s61, v152
    v_lshlrev_b32 v86, 16, v153
    v_and_b32 v87, s61, v153
    v_lshlrev_b32 v88, 16, v154
    v_and_b32 v89, s61, v154
    v_lshlrev_b32 v90, 16, v155
    v_and_b32 v91, s61, v155
    v_fmac_f32 v76, v65, v84
    v_fmac_f32 v77, v65, v85
    v_fmac_f32 v78, v65, v86
    v_fmac_f32 v79, v65, v87
    v_fmac_f32 v80, v65, v88
    v_fmac_f32 v81, v65, v89
    v_fmac_f32 v82, v65, v90
    v_fmac_f32 v83, v65, v91
    s_waitcnt vmcnt(9)
    v_lshlrev_b32 v84, 16, v156
    v_and_b32 v85, s61, v156
    v_lshlrev_b32 v86, 16, v157
    v_and_b32 v87, s61, v157
    v_lshlrev_b32 v88, 16, v158
    v_and_b32 v89, s61, v158
    v_lshlrev_b32 v90, 16, v159
    v_and_b32 v91, s61, v159
    v_fmac_f32 v76, v66, v84
    v_fmac_f32 v77, v66, v85
    v_fmac_f32 v78, v66, v86
    v_fmac_f32 v79, v66, v87
    v_fmac_f32 v80, v66, v88
    v_fmac_f32 v81, v66, v89
    v_fmac_f32 v82, v66, v90
    v_fmac_f32 v83, v66, v91
    s_waitcnt vmcnt(8)
    v_lshlrev_b32 v84, 16, v160
    v_and_b32 v85, s61, v160
    v_lshlrev_b32 v86, 16, v161
    v_and_b32 v87, s61, v161
    v_lshlrev_b32 v88, 16, v162
    v_and_b32 v89, s61, v162
    v_lshlrev_b32 v90, 16, v163
    v_and_b32 v91, s61, v163
    v_fmac_f32 v76, v67, v84
    v_fmac_f32 v77, v67, v85
    v_fmac_f32 v78, v67, v86
    v_fmac_f32 v79, v67, v87
    v_fmac_f32 v80, v67, v88
    v_fmac_f32 v81, v67, v89
    v_fmac_f32 v82, v67, v90
    v_fmac_f32 v83, v67, v91
    s_waitcnt vmcnt(7)
    v_lshlrev_b32 v84, 16, v100
    v_and_b32 v85, s61, v100
    v_lshlrev_b32 v86, 16, v101
    v_and_b32 v87, s61, v101
    v_lshlrev_b32 v88, 16, v102
    v_and_b32 v89, s61, v102
    v_lshlrev_b32 v90, 16, v103
    v_and_b32 v91, s61, v103
    v_fmac_f32 v76, v68, v84
    v_fmac_f32 v77, v68, v85
    v_fmac_f32 v78, v68, v86
    v_fmac_f32 v79, v68, v87
    v_fmac_f32 v80, v68, v88
    v_fmac_f32 v81, v68, v89
    v_fmac_f32 v82, v68, v90
    v_fmac_f32 v83, v68, v91
    s_waitcnt vmcnt(6)
    v_lshlrev_b32 v84, 16, v104
    v_and_b32 v85, s61, v104
    v_lshlrev_b32 v86, 16, v105
    v_and_b32 v87, s61, v105
    v_lshlrev_b32 v88, 16, v106
    v_and_b32 v89, s61, v106
    v_lshlrev_b32 v90, 16, v107
    v_and_b32 v91, s61, v107
    v_fmac_f32 v76, v69, v84
    v_fmac_f32 v77, v69, v85
    v_fmac_f32 v78, v69, v86
    v_fmac_f32 v79, v69, v87
    v_fmac_f32 v80, v69, v88
    v_fmac_f32 v81, v69, v89
    v_fmac_f32 v82, v69, v90
    v_fmac_f32 v83, v69, v91
    s_waitcnt vmcnt(5)
    v_lshlrev_b32 v84, 16, v108
    v_and_b32 v85, s61, v108
    v_lshlrev_b32 v86, 16, v109
    v_and_b32 v87, s61, v109
    v_lshlrev_b32 v88, 16, v110
    v_and_b32 v89, s61, v110
    v_lshlrev_b32 v90, 16, v111
    v_and_b32 v91, s61, v111
    v_fmac_f32 v76, v70, v84
    v_fmac_f32 v77, v70, v85
    v_fmac_f32 v78, v70, v86
    v_fmac_f32 v79, v70, v87
    v_fmac_f32 v80, v70, v88
    v_fmac_f32 v81, v70, v89
    v_fmac_f32 v82, v70, v90
    v_fmac_f32 v83, v70, v91
    s_waitcnt vmcnt(4)
    v_lshlrev_b32 v84, 16, v112
    v_and_b32 v85, s61, v112
    v_lshlrev_b32 v86, 16, v113
    v_and_b32 v87, s61, v113
    v_lshlrev_b32 v88, 16, v114
    v_and_b32 v89, s61, v114
    v_lshlrev_b32 v90, 16, v115
    v_and_b32 v91, s61, v115
    v_fmac_f32 v76, v71, v84
    v_fmac_f32 v77, v71, v85
    v_fmac_f32 v78, v71, v86
    v_fmac_f32 v79, v71, v87
    v_fmac_f32 v80, v71, v88
    v_fmac_f32 v81, v71, v89
    v_fmac_f32 v82, v71, v90
    v_fmac_f32 v83, v71, v91
    s_waitcnt vmcnt(3)
    v_lshlrev_b32 v84, 16, v116
    v_and_b32 v85, s61, v116
    v_lshlrev_b32 v86, 16, v117
    v_and_b32 v87, s61, v117
    v_lshlrev_b32 v88, 16, v118
    v_and_b32 v89, s61, v118
    v_lshlrev_b32 v90, 16, v119
    v_and_b32 v91, s61, v119
    v_fmac_f32 v76, v72, v84
    v_fmac_f32 v77, v72, v85
    v_fmac_f32 v78, v72, v86
    v_fmac_f32 v79, v72, v87
    v_fmac_f32 v80, v72, v88
    v_fmac_f32 v81, v72, v89
    v_fmac_f32 v82, v72, v90
    v_fmac_f32 v83, v72, v91
    s_waitcnt vmcnt(2)
    v_lshlrev_b32 v84, 16, v120
    v_and_b32 v85, s61, v120
    v_lshlrev_b32 v86, 16, v121
    v_and_b32 v87, s61, v121
    v_lshlrev_b32 v88, 16, v122
    v_and_b32 v89, s61, v122
    v_lshlrev_b32 v90, 16, v123
    v_and_b32 v91, s61, v123
    v_fmac_f32 v76, v73, v84
    v_fmac_f32 v77, v73, v85
    v_fmac_f32 v78, v73, v86
    v_fmac_f32 v79, v73, v87
    v_fmac_f32 v80, v73, v88
    v_fmac_f32 v81, v73, v89
    v_fmac_f32 v82, v73, v90
    v_fmac_f32 v83, v73, v91
    s_waitcnt vmcnt(1)
    v_lshlrev_b32 v84, 16, v124
    v_and_b32 v85, s61, v124
    v_lshlrev_b32 v86, 16, v125
    v_and_b32 v87, s61, v125
    v_lshlrev_b32 v88, 16, v126
    v_and_b32 v89, s61, v126
    v_lshlrev_b32 v90, 16, v127
    v_and_b32 v91, s61, v127
    v_fmac_f32 v76, v74, v84
    v_fmac_f32 v77, v74, v85
    v_fmac_f32 v78, v74, v86
    v_fmac_f32 v79, v74, v87
    v_fmac_f32 v80, v74, v88
    v_fmac_f32 v81, v74, v89
    v_fmac_f32 v82, v74, v90
    v_fmac_f32 v83, v74, v91
    s_waitcnt vmcnt(0)
    v_lshlrev_b32 v84, 16, v128
    v_and_b32 v85, s61, v128
    v_lshlrev_b32 v86, 16, v129
    v_and_b32 v87, s61, v129
    v_lshlrev_b32 v88, 16, v130
    v_and_b32 v89, s61, v130
    v_lshlrev_b32 v90, 16, v131
    v_and_b32 v91, s61, v131
    v_fmac_f32 v76, v75, v84
    v_fmac_f32 v77, v75, v85
    v_fmac_f32 v78, v75, v86
    v_fmac_f32 v79, v75, v87
    v_fmac_f32 v80, v75, v88
    v_fmac_f32 v81, v75, v89
    v_fmac_f32 v82, v75, v90
    v_fmac_f32 v83, v75, v91
L_join:
    v_mov_b32 v95, v94
    s_nop 1
    v_permlane32_swap_b32 v76, v80
    v_permlane32_swap_b32 v77, v81
    v_permlane32_swap_b32 v78, v82
    v_permlane32_swap_b32 v79, v83
    v_permlane32_swap_b32 v94, v95
    s_nop 1
    v_add_f32 v76, v76, v80
    v_add_f32 v77, v77, v81
    v_add_f32 v78, v78, v82
    v_add_f32 v79, v79, v83
    v_add_f32 v94, v94, v95
    v_mov_b32 v95, v94
    s_nop 1
    v_permlane16_swap_b32 v76, v78
    v_permlane16_swap_b32 v77, v79
    v_permlane16_swap_b32 v94, v95
    s_nop 1
    v_add_f32 v76, v76, v78
    v_add_f32 v77, v77, v79
    v_add_f32 v93, v94, v95
    v_and_b32 v84, 15, v3
    v_lshlrev_b32 v84, 5, v84
    v_lshrrev_b32 v85, 4, v3
    v_lshl_add_u32 v84, v85, 3, v84
    s_lshl_b32 s62, s19, 9
    v_add_u32 v84, s62, v84
    ds_write_b64 v84, v[76:77]
    s_lshl_b32 s62, s19, 3
    s_add_u32 s62, s62, 4096
    v_mov_b32 v86, s62
    ds_write_b64 v86, v[92:93]
    s_waitcnt lgkmcnt(0)
    s_barrier
    s_cmp_lg_u32 s19, 0
    s_cbranch_scc1 L_done
    v_and_b32 v84, 7, v3
    v_lshlrev_b32 v84, 3, v84
    ds_read_b64 v[92:93], v84 offset:4096
    v_lshlrev_b32 v85, 3, v3
    ds_read_b64 v[100:101], v85 offset:0
    ds_read_b64 v[102:103], v85 offset:512
    ds_read_b64 v[104:105], v85 offset:1024
    ds_read_b64 v[106:107], v85 offset:1536
    ds_read_b64 v[108:109], v85 offset:2048
    ds_read_b64 v[110:111], v85 offset:2560
    ds_read_b64 v[112:113], v85 offset:3072
    ds_read_b64 v[114:115], v85 offset:3584
    s_waitcnt lgkmcnt(8)
    v_mov_b32 v94, v92
    s_nop 1
    v_max_f32_dpp v94, v94, v94 row_ror:4 row_mask:0xf bank_mask:0xf
    s_nop 1
    v_max_f32_dpp v94, v94, v94 row_ror:2 row_mask:0xf bank_mask:0xf
    s_nop 1
    v_max_f32_dpp v94, v94, v94 row_ror:1 row_mask:0xf bank_mask:0xf
    s_nop 1
    v_sub_f32 v95, v92, v94
    v_mul_f32 v95, s60, v95
    v_exp_f32 v95, v95
    s_nop 0
    v_mul_f32 v96, v93, v95
    s_nop 1
    v_add_f32_dpp v96, v96, v96 row_ror:4 row_mask:0xf bank_mask:0xf
    s_nop 1
    v_add_f32_dpp v96, v96, v96 row_ror:2 row_mask:0xf bank_mask:0xf
    s_nop 1
    v_add_f32_dpp v96, v96, v96 row_ror:1 row_mask:0xf bank_mask:0xf
    s_nop 1
    v_readlane_b32 s64, v95, 0
    v_readlane_b32 s65, v95, 1
    v_readlane_b32 s66, v95, 2
    v_readlane_b32 s67, v95, 3
    v_readlane_b32 s68, v95, 4
    v_readlane_b32 s69, v95, 5
    v_readlane_b32 s70, v95, 6
    v_readlane_b32 s71, v95, 7
    s_waitcnt lgkmcnt(0)
    v_mul_f32 v76, s64, v100
    v_mul_f32 v77, s64, v101
    v_fmac_f32 v76, s65, v102
    v_fmac_f32 v77, s65, v103
    v_fmac_f32 v76, s66, v104
    v_fmac_f32 v77, s66, v105
    v_fmac_f32 v76, s67, v106
    v_fmac_f32 v77, s67, v107
    v_fmac_f32 v76, s68, v108
    v_fmac_f32 v77, s68, v109
    v_fmac_f32 v76, s69, v110
    v_fmac_f32 v77, s69, v111
    v_fmac_f32 v76, s70, v112
    v_fmac_f32 v77, s70, v113
    v_fmac_f32 v76, s71, v114
    v_fmac_f32 v77, s71, v115
    v_mov_b32 v78, v94
    v_mov_b32 v79, v96
    s_mul_i32 s62, s17, 2
    s_add_u32 s63, s62, s18
    s_lshl_b32 s63, s63, 10
    s_lshl_b32 s62, s62, 10
    v_lshlrev_b32 v84, 4, v3
    buffer_store_dwordx4 v[76:79], v84, s[56:59], s63 offen sc0 sc1
    s_waitcnt vmcnt(0)
    s_lshl_b32 s82, 1, s81
    v_mov_b32 v86, s82
    v_mov_b32 v87, s80
    s_mov_b64 exec, 1
    buffer_atomic_add v86, v87, s[52:55], 0 offen sc0 sc1
    s_mov_b64 exec, -1
    s_waitcnt vmcnt(0)
    v_readfirstlane_b32 s83, v86
    s_nop 3
    s_lshr_b32 s83, s83, s81
    s_and_b32 s83, s83, 0xff
    s_cmp_lg_u32 s83, 1
    s_cbranch_scc1 L_done
    buffer_load_dwordx4 v[100:103], v84, s[56:59], s62 offen offset:0 sc0 sc1
    buffer_load_dwordx4 v[104:107], v84, s[56:59], s62 offen offset:1024 sc0 sc1
    s_waitcnt vmcnt(0)
    v_max_f32 v94, v102, v106
    v_sub_f32 v102, v102, v94
    v_mul_f32 v102, s60, v102
    v_exp_f32 v102, v102
    v_sub_f32 v106, v106, v94
    v_mul_f32 v106, s60, v106
    v_exp_f32 v106, v106
    s_nop 0
    v_mul_f32 v76, v100, v102
    v_mul_f32 v77, v101, v102
    v_mul_f32 v78, v103, v102
    v_fmac_f32 v76, v104, v106
    v_fmac_f32 v77, v105, v106
    v_fmac_f32 v78, v107, v106
    v_rcp_f32 v78, v78
    s_nop 0
    v_mul_f32 v76, v76, v78
    v_mul_f32 v77, v77, v78
    v_cvt_pk_bf16_f32 v76, v76, v77
    v_lshlrev_b32 v85, 2, v3
    buffer_store_dword v76, v85, s[48:51], s22 offen
L_done:
    s_endpgm
.section .rodata,"a"
.p2align 6
.amdhsa_kernel standalone__softmax_full_bidir__decode_kernel
  .amdhsa_next_free_vgpr 168
  .amdhsa_next_free_sgpr 96
  .amdhsa_accum_offset 168
  .amdhsa_group_segment_fixed_size 0
  .amdhsa_kernarg_size 48
  .amdhsa_user_sgpr_count 2
  .amdhsa_user_sgpr_kernarg_segment_ptr 1
  .amdhsa_system_sgpr_workgroup_id_x 1
.end_amdhsa_kernel
```
